```python
import torch

def _softmax(x, axis=-1):
    return torch.softmax(x, dim=axis)
def _gelu(x):
    return torch.nn.functional.gelu(x, approximate="tanh")
def _silu(x):
    return torch.nn.functional.silu(x)
def _sigmoid(x):
    return torch.sigmoid(x)
def _layernorm(x, axis=-1, eps=1e-5):
    m = x.mean(dim=axis, keepdim=True)
    v = x.var(dim=axis, keepdim=True, unbiased=False)
    return (x - m) / torch.sqrt(v + eps)
def _scatter_add(tgt, idx, src, axis=0):
    return tgt.clone().index_add_(axis, idx, src)
def _segment_sum(src, seg, n):
    out = torch.zeros((n,) + src.shape[1:], dtype=src.dtype)
    return out.index_add_(0, seg, src)
def _pad(x, pw):
    flat = tuple(v for pair in reversed(pw) for v in pair)
    return torch.nn.functional.pad(x, flat)

kernel_name = 'gated_mix__mha_block__ssm_conv_s4d__prompt'

def setup_inputs():

    _w = (lambda a: (lambda t: t.to(torch.bfloat16) if t.is_floating_point() else t)(torch.as_tensor(a)))
    def _A_setup():
        B, S, D, H = 1, 2048, 448, 16
        return {
            "x": _w((lambda *s: torch.randn(*s, dtype=torch.bfloat16) * 0.05)(B, S, D)),
            "wqkv": _w((lambda *s: torch.randn(*s, dtype=torch.bfloat16) * 0.8)(D, 3 * D)),
            "wo": _w((lambda *s: torch.randn(*s, dtype=torch.bfloat16) * 0.05)(D, D)),
        }
    _A_in = _A_setup()

    def _B_setup():
        Bsz, L, D, N = 1, 2048, 448, 256
        return {
            "u": _w((lambda *s: torch.randn(*s, dtype=torch.bfloat16) * 0.05)(Bsz, L, D)),
            "log_A_real": _w((lambda *s: torch.randn(*s, dtype=torch.bfloat16) * 3.2)(D, N) * 0.5),
            "A_imag": _w((lambda *s: torch.randn(*s, dtype=torch.bfloat16) * 0.05)(D, N) * 3.14),
            "C_real": _w((lambda *s: torch.randn(*s, dtype=torch.bfloat16) * 0.8)(D, N) / N ** 0.5),
            "C_imag": _w((lambda *s: torch.randn(*s, dtype=torch.bfloat16) * 0.8)(D, N) / N ** 0.5),
            "log_dt": _w((lambda *s: torch.randn(*s, dtype=torch.bfloat16) * 0.05)(D) * 0.5 - 4.0),
            "D_skip": _w((lambda *s: torch.randn(*s, dtype=torch.bfloat16) * 0.1)(D)),
        }
    _B_in = _B_setup()

    return {
        "A_x": _A_in["x"],
        "A_wqkv": _A_in["wqkv"],
        "A_wo": _A_in["wo"],
        "B_u": _B_in["u"],
        "B_log_A_real": _B_in["log_A_real"],
        "B_A_imag": _B_in["A_imag"],
        "B_C_real": _B_in["C_real"],
        "B_C_imag": _B_in["C_imag"],
        "B_log_dt": _B_in["log_dt"],
        "B_D_skip": _B_in["D_skip"],
        "gate_w": _w((lambda *s: torch.randn(*s, dtype=torch.bfloat16) * 0.05)(448) * 16.0),
    }

def reference(A_x, A_wqkv, A_wo, B_u, B_log_A_real, B_A_imag, B_C_real, B_C_imag, B_log_dt, B_D_skip, gate_w):
    def _A_ref(x, wqkv, wo):
        B, S, D = x.shape
        H = 16
        Dh = D // H
        qkv = (lambda x, *d: x.permute(*d))((x @ wqkv).reshape(B, S, 3, H, Dh), 2, 0, 3, 1, 4)
        q, k, v = qkv[0], qkv[1], qkv[2]
        scores = torch.einsum("bhqd,bhkd->bhqk", q, k) * (Dh ** -0.5)
        p = _softmax(scores, axis=-1)
        o = torch.einsum("bhqk,bhkd->bhqd", p, v)
        return (lambda x, *d: x.permute(*d))(o, 0, 2, 1, 3).reshape(B, S, D) @ wo

    def _B_ref(u, log_A_real, A_imag, C_real, C_imag, log_dt, D_skip):
        L = u.shape[1]
        dt = torch.exp(log_dt)
        A = -torch.exp(log_A_real) + 1j * A_imag
        C = (C_real + 1j * C_imag) * dt[:, None]
        pos = (lambda x, dt: x.to(dt))(torch.arange(L), log_dt.dtype)
        P = torch.exp((A * dt[:, None])[:, :, None] * pos[None, None, :])
        K = 2.0 * torch.einsum("dn,dnl->dl", C, P).real
        L2 = 2 * L
        u_t = (lambda x, *d: x.permute(*d))(u, 0, 2, 1)
        Kf = (lambda x, *a, **k: torch.fft.rfft(x.float(), *a, **k))(K, L2)
        Uf = (lambda x, *a, **k: torch.fft.rfft(x.float(), *a, **k))(u_t, L2)
        y = (lambda x, *a, **k: torch.fft.irfft(x, *a, **k).to(torch.bfloat16))(Uf * Kf[None, :, :], L2)[:, :, :L]
        y = (lambda x, *d: x.permute(*d))(y, 0, 2, 1)
        return y + u * D_skip[None, None, :]

    x = A_x
    g = _sigmoid((x * gate_w).sum(-1, keepdims=True))
    a = _A_ref(x, A_wqkv, A_wo)
    b = _B_ref(x, B_log_A_real, B_A_imag, B_C_real, B_C_imag, B_log_dt, B_D_skip)
    return g * a + (1 - g) * b
```

```asm
; @launch grid=(256,1,1) block=(512,1,1) lds=163840
.amdgcn_target "amdgcn-amd-amdhsa--gfx950"
.text
.globl gated_mix__mha_block__ssm_conv_s4d__prompt_kernel
.type gated_mix__mha_block__ssm_conv_s4d__prompt_kernel,@function
.p2align 8
gated_mix__mha_block__ssm_conv_s4d__prompt_kernel:
    s_load_dwordx16 s[16:31], s[0:1], 32
    s_load_dwordx2 s[4:5], s[0:1], 0
    s_load_dwordx2 s[8:9], s[0:1], 8
    s_getpc_b64 s[66:67]
E_pc:
    s_cmp_ge_u32 s2, 256
    s_cbranch_scc1 L_end
    s_lshr_b32 s3, s2, 3
    s_lshl_b32 s3, s3, 7
    v_lshl_add_u32 v4, v0, 6, s3
    v_min_u32 v4, L_code_end-E_pc-4, v4
    s_mov_b64 exec, 1
    global_load_dword v8, v4, s[66:67]
    s_mov_b64 exec, -1
    s_load_dwordx2 s[12:13], s[0:1], 104
    s_load_dwordx2 s[48:49], s[0:1], 96
    s_load_dwordx2 s[52:53], s[0:1], 16
    s_load_dwordx2 s[56:57], s[0:1], 88
    s_memrealtime s[64:65]
    v_lshrrev_b32 v1, 6, v0
    v_and_b32 v0, 63, v0
    v_readfirstlane_b32 s3, v1
    s_mov_b32 s7, 0x20000
    s_mov_b32 s6, 1835008
    s_mov_b32 s10, 1204224
    s_mov_b32 s11, s7
    s_mov_b32 s14, 16777216
    s_mov_b32 s15, s7
    s_mov_b32 s54, 401408
    s_mov_b32 s55, s7
    s_mov_b32 s58, s6
    s_mov_b32 s59, s7
    v_lshlrev_b32 v1, 4, v0
    v_and_b32 v2, 31, v0
    v_lshrrev_b32 v3, 5, v0
    s_bfe_u32 s32, s2, 0x20003
    s_and_b32 s34, s2, 4
    s_add_u32 s34, s34, s32
    s_lshr_b32 s33, s2, 5
    s_and_b32 s35, s2, 3
    s_lshl3_add_u32 s35, s35, s33
    s_bfe_u32 s36, s2, 0x10005
    s_lshl_b32 s36, s36, 2
    s_xor_b32 s36, s36, s34
    s_cmp_eq_u32 s32, 3
    s_cselect_b32 s34, s36, s34
    s_lshl_b32 s61, s34, 5
    s_add_u32 s61, s61, s35
    s_lshl_b32 s61, s61, 7
    s_getreg_b32 s68, hwreg(HW_REG_XCC_ID, 0, 3)
    s_cmp_eq_u32 s34, 7
    s_cbranch_scc1 L_gate
    s_cmp_lt_u32 s3, 4
    s_cbranch_scc1 L_main
    s_sub_u32 s3, s3, 4
    s_lshr_b32 s39, s61, 5
    s_add_u32 s40, s39, s3
    s_lshl_b32 s40, s40, 8
    v_lshlrev_b32 v27, 2, v0
    v_add_u32 v26, s40, v27
    v_mov_b32 v10, 0
    ds_write_b32 v27, v10 offset:61440
    s_waitcnt lgkmcnt(0)
    global_load_dword v12, v26, s[16:17]
    global_load_dword v13, v26, s[18:19]
    global_load_dword v14, v26, s[20:21]
    global_load_dword v15, v26, s[22:23]
    s_barrier
    s_load_dword s44, s[24:25], s39
    s_load_dword s45, s[26:27], s39
    s_branch L_aux
L_main:
    s_setprio 2
    v_lshrrev_b32 v20, 3, v0
    s_lshl_b32 s37, s3, 4
    v_add_u32 v20, s37, v20
    s_lshl_b32 s36, s35, 6
    v_add_u32 v22, s36, v20
    v_mul_u32_u24 v22, 896, v22
    v_lshrrev_b32 v21, 4, v0
    v_xor_b32 v21, v21, v0
    v_and_b32 v21, 7, v21
    v_lshl_add_u32 v4, v21, 4, v22
    v_xor_b32 v21, 4, v21
    v_lshl_add_u32 v5, v21, 4, v22
    v_add_u32 v5, 6144, v5
    v_mul_u32_u24 v20, 2688, v20
    v_lshrrev_b32 v22, 2, v0
    v_and_b32 v22, 4, v22
    v_xor_b32 v22, v22, v0
    v_and_b32 v22, 7, v22
    v_lshl_add_u32 v20, v22, 4, v20
    s_mul_i32 s39, s33, 1
    s_mul_i32 s36, s32, 2
    s_add_u32 s39, s39, s36
    s_mul_i32 s36, s39, 37
    s_lshr_b32 s36, s36, 8
    s_mul_i32 s36, s36, 7
    s_sub_u32 s39, s39, s36
    s_lshr_b32 s38, s33, 1
    s_xor_b32 s38, s38, s33
    s_and_b32 s38, s38, 1
    s_add_u32 s38, s38, 1
    s_mul_i32 s36, s38, 896
    v_add_u32 v12, s36, v20
    v_add_u32 v13, 20480, v12
    s_mul_i32 s40, s34, 128
    s_lshl_b32 s41, s3, 11
    s_add_u32 s41, s41, 65536
    s_lshl_b32 s46, s39, 7
    s_mul_i32 s47, s39, 172032
    s_add_u32 s47, s47, s40
    s_waitcnt lgkmcnt(0)
    s_mov_b32 s16, s46
    s_mov_b32 s23, s47
    s_add_u32 s17, s16, 128
    s_add_u32 s24, s23, 172032
    s_cmp_eq_u32 s17, 896
    s_cselect_b32 s17, 0, s17
    s_cselect_b32 s24, s40, s24
    s_barrier
    s_add_u32 m0, s41, 0
    s_nop 0
    buffer_load_dwordx4 v4, s[4:7], s16 offen offset:0 lds
    buffer_load_dwordx4 v5, s[4:7], s16 offen offset:1024 lds
    s_add_u32 m0, s41, 8192
    s_nop 0
    buffer_load_dwordx4 v12, s[8:11], s23 offen offset:0 lds
    buffer_load_dwordx4 v13, s[8:11], s23 offen offset:1024 lds
    s_add_u32 m0, s41, 16384
    s_nop 0
    buffer_load_dwordx4 v4, s[4:7], s17 offen offset:0 lds
    buffer_load_dwordx4 v5, s[4:7], s17 offen offset:1024 lds
    s_add_u32 m0, s41, 24576
    s_nop 0
    buffer_load_dwordx4 v12, s[8:11], s24 offen offset:0 lds
    buffer_load_dwordx4 v13, s[8:11], s24 offen offset:1024 lds
    s_add_u32 s18, s17, 128
    s_add_u32 s25, s24, 172032
    s_cmp_eq_u32 s18, 896
    s_cselect_b32 s18, 0, s18
    s_cselect_b32 s25, s40, s25
    s_add_u32 s19, s18, 128
    s_add_u32 s26, s25, 172032
    s_cmp_eq_u32 s19, 896
    s_cselect_b32 s19, 0, s19
    s_cselect_b32 s26, s40, s26
    s_add_u32 s20, s19, 128
    s_add_u32 s27, s26, 172032
    s_cmp_eq_u32 s20, 896
    s_cselect_b32 s20, 0, s20
    s_cselect_b32 s27, s40, s27
    s_add_u32 s21, s20, 128
    s_add_u32 s32, s27, 172032
    s_cmp_eq_u32 s21, 896
    s_cselect_b32 s21, 0, s21
    s_cselect_b32 s32, s40, s32
    s_add_u32 s22, s21, 128
    s_add_u32 s33, s32, 172032
    s_cmp_eq_u32 s22, 896
    s_cselect_b32 s22, 0, s22
    s_cselect_b32 s33, s40, s33
    s_and_b32 s44, s3, 1
    s_lshr_b32 s45, s3, 1
    v_bfe_u32 v22, v0, 1, 3
    v_xor_b32 v22, v22, v3
    v_lshlrev_b32 v22, 4, v22
    v_lshl_add_u32 v22, v2, 7, v22
    s_lshl_b32 s36, s44, 12
    s_add_u32 s36, s36, 65536
    v_add_u32 v24, s36, v22
    v_xor_b32 v25, 32, v24
    v_xor_b32 v26, 64, v24
    v_xor_b32 v27, 96, v24
    v_bfe_u32 v21, v0, 2, 2
    v_lshl_add_u32 v21, v3, 3, v21
    v_lshlrev_b32 v21, 7, v21
    v_and_b32 v22, 16, v0
    v_lshl_add_u32 v21, v22, 1, v21
    v_and_b32 v22, 3, v0
    v_lshl_add_u32 v21, v22, 3, v21
    v_and_b32 v22, 8, v0
    v_lshl_add_u32 v21, v22, 3, v21
    s_lshl_b32 s36, s45, 6
    v_xor_b32 v21, s36, v21
    v_add_u32 v32, 65536, v21
    v_add_u32 v33, 131072, v21
    v_mov_b32 v10, 0
    v_mul_u32_u24 v21, 576, v3
    v_lshlrev_b32 v22, 4, v2
    v_xor_b32 v34, v21, v22
    v_xor_b32 v35, 128, v34
    s_lshl1_add_u32 s36, s35, s44
    s_mul_i32 s36, s36, 86016
    s_lshl_b32 s37, s45, 11
    s_add_u32 s36, s36, s37
    s_mul_i32 s37, s34, 3
    v_add_u32 v28, 65536, v24
    v_add_u32 v29, 65536, v25
    v_add_u32 v30, 65536, v26
    v_add_u32 v31, 65536, v27
    s_mul_i32 s39, s38, 7
    s_add_u32 s39, s39, s34
    s_cmp_ge_u32 s39, 14
    s_cselect_b32 s46, 1, 0
    s_mov_b32 s51, s46
    s_lshl_b32 s28, s39, 12
    s_add_u32 s28, s28, s36
    s_sub_u32 s38, 3, s38
    s_mul_i32 s39, s38, 896
    v_add_u32 v14, s39, v20
    v_add_u32 v15, 20480, v14
    s_mul_i32 s39, s38, 7
    s_add_u32 s39, s39, s34
    s_lshl_b32 s29, s39, 12
    s_add_u32 s29, s29, s36
    s_mov_b32 s38, 0
    s_mul_i32 s39, s38, 896
    v_add_u32 v16, s39, v20
    v_add_u32 v17, 20480, v16
    s_mul_i32 s39, s38, 7
    s_add_u32 s39, s39, s34
    s_lshl_b32 s42, s39, 12
    s_add_u32 s42, s42, s36
    s_mov_b32 s30, 0x3e8b97f6
    v_mov_b32 v232, 0
    s_mov_b32 exec_lo, 0x10000000
    s_mov_b32 exec_hi, 0x10000000
    v_mov_b32 v232, 0x3f803f80
    s_mov_b64 exec, -1
    v_mov_b32 v233, v232
    v_mov_b64 v[234:235], v[232:233]
    v_mov_b64 v[236:237], v[232:233]
    v_mov_b64 v[238:239], v[232:233]
    v_mov_b64 v[240:241], v[232:233]
    v_mov_b64 v[242:243], v[232:233]
    v_mov_b64 v[244:245], v[232:233]
    v_mov_b64 v[246:247], v[232:233]
    v_mov_b64 v[248:249], v[232:233]
    v_mov_b64 v[250:251], v[232:233]
    v_mov_b64 v[252:253], v[232:233]
    v_mov_b64 v[254:255], v[232:233]
    s_add_u32 m0, s41, 32768
    s_nop 0
    buffer_load_dwordx4 v4, s[4:7], s18 offen offset:0 lds
    buffer_load_dwordx4 v5, s[4:7], s18 offen offset:1024 lds
    s_add_u32 m0, s41, 40960
    s_nop 0
    buffer_load_dwordx4 v12, s[8:11], s25 offen offset:0 lds
    buffer_load_dwordx4 v13, s[8:11], s25 offen offset:1024 lds
    s_add_u32 m0, s41, 49152
    s_nop 0
    buffer_load_dwordx4 v4, s[4:7], s19 offen offset:0 lds
    buffer_load_dwordx4 v5, s[4:7], s19 offen offset:1024 lds
    s_add_u32 m0, s41, 57344
    s_nop 0
    buffer_load_dwordx4 v12, s[8:11], s26 offen offset:0 lds
    buffer_load_dwordx4 v13, s[8:11], s26 offen offset:1024 lds
    s_waitcnt vmcnt(8) lgkmcnt(0)
    s_barrier
    ds_read_b128 v[120:123], v24 offset:0
    ds_read_b64_tr_b16 v[40:41], v32 offset:8192
    ds_read_b64_tr_b16 v[42:43], v32 offset:8704
    ds_read_b128 v[124:127], v25 offset:0
    ds_read_b64_tr_b16 v[44:45], v32 offset:10240
    ds_read_b64_tr_b16 v[46:47], v32 offset:10752
    ds_read_b128 v[128:131], v26 offset:0
    ds_read_b64_tr_b16 v[48:49], v32 offset:12288
    ds_read_b64_tr_b16 v[50:51], v32 offset:12800
    s_bitcmp1_b32 s51, 0
    s_cbranch_scc1 G_vk
    s_waitcnt lgkmcnt(6)
    v_mfma_f32_32x32x16_bf16 v[56:71], v[40:43], v[120:123], 0
    s_add_u32 m0, s41, 65536
    ds_read_b128 v[132:135], v27 offset:0
    ds_read_b64_tr_b16 v[52:53], v32 offset:14336
    ds_read_b64_tr_b16 v[54:55], v32 offset:14848
    buffer_load_dwordx4 v4, s[4:7], s20 offen offset:0 lds
    s_waitcnt lgkmcnt(6)
    v_mfma_f32_32x32x16_bf16 v[56:71], v[44:47], v[124:127], v[56:71]
    ds_read_b128 v[136:139], v24 offset:16384
    ds_read_b64_tr_b16 v[40:41], v32 offset:24576
    ds_read_b64_tr_b16 v[42:43], v32 offset:25088
    buffer_load_dwordx4 v5, s[4:7], s20 offen offset:1024 lds
    s_waitcnt lgkmcnt(6)
    v_mfma_f32_32x32x16_bf16 v[56:71], v[48:51], v[128:131], v[56:71]
    s_add_u32 m0, s41, 73728
    ds_read_b128 v[140:143], v25 offset:16384
    ds_read_b64_tr_b16 v[44:45], v32 offset:26624
    ds_read_b64_tr_b16 v[46:47], v32 offset:27136
    buffer_load_dwordx4 v12, s[8:11], s27 offen offset:0 lds
    s_waitcnt lgkmcnt(6)
    v_mfma_f32_32x32x16_bf16 v[56:71], v[52:55], v[132:135], v[56:71]
    ds_read_b128 v[144:147], v26 offset:16384
    ds_read_b64_tr_b16 v[48:49], v32 offset:28672
    ds_read_b64_tr_b16 v[50:51], v32 offset:29184
    buffer_load_dwordx4 v13, s[8:11], s27 offen offset:1024 lds
    s_waitcnt lgkmcnt(6)
    v_mfma_f32_32x32x16_bf16 v[56:71], v[40:43], v[136:139], v[56:71]
    s_add_u32 m0, s41, 81920
    ds_read_b128 v[148:151], v27 offset:16384
    ds_read_b64_tr_b16 v[52:53], v32 offset:30720
    ds_read_b64_tr_b16 v[54:55], v32 offset:31232
    buffer_load_dwordx4 v4, s[4:7], s21 offen offset:0 lds
    s_waitcnt lgkmcnt(6)
    v_mfma_f32_32x32x16_bf16 v[56:71], v[44:47], v[140:143], v[56:71]
    s_nop 0
    buffer_load_dwordx4 v5, s[4:7], s21 offen offset:1024 lds
    s_add_u32 m0, s41, 90112
    s_nop 0
    buffer_load_dwordx4 v12, s[8:11], s32 offen offset:0 lds
    buffer_load_dwordx4 v13, s[8:11], s32 offen offset:1024 lds
    s_waitcnt vmcnt(8) lgkmcnt(0)
    s_barrier
    ds_read_b128 v[152:155], v24 offset:32768
    ds_read_b64_tr_b16 v[40:41], v32 offset:40960
    ds_read_b64_tr_b16 v[42:43], v32 offset:41472
    v_mfma_f32_32x32x16_bf16 v[56:71], v[48:51], v[144:147], v[56:71]
    s_add_u32 m0, s41, 0
    ds_read_b128 v[156:159], v25 offset:32768
    ds_read_b64_tr_b16 v[44:45], v32 offset:43008
    ds_read_b64_tr_b16 v[46:47], v32 offset:43520
    buffer_load_dwordx4 v4, s[4:7], s22 offen offset:0 lds
    v_mfma_f32_32x32x16_bf16 v[56:71], v[52:55], v[148:151], v[56:71]
    ds_read_b128 v[160:163], v26 offset:32768
    ds_read_b64_tr_b16 v[48:49], v32 offset:45056
    ds_read_b64_tr_b16 v[50:51], v32 offset:45568
    buffer_load_dwordx4 v5, s[4:7], s22 offen offset:1024 lds
    s_waitcnt lgkmcnt(6)
    v_mfma_f32_32x32x16_bf16 v[56:71], v[40:43], v[152:155], v[56:71]
    s_add_u32 m0, s41, 8192
    ds_read_b128 v[164:167], v27 offset:32768
    ds_read_b64_tr_b16 v[52:53], v32 offset:47104
    ds_read_b64_tr_b16 v[54:55], v32 offset:47616
    buffer_load_dwordx4 v12, s[8:11], s33 offen offset:0 lds
    s_waitcnt lgkmcnt(6)
    v_mfma_f32_32x32x16_bf16 v[56:71], v[44:47], v[156:159], v[56:71]
    ds_read_b128 v[168:171], v24 offset:49152
    ds_read_b64_tr_b16 v[40:41], v32 offset:57344
    ds_read_b64_tr_b16 v[42:43], v32 offset:57856
    buffer_load_dwordx4 v13, s[8:11], s33 offen offset:1024 lds
    s_waitcnt lgkmcnt(6)
    v_mfma_f32_32x32x16_bf16 v[56:71], v[48:51], v[160:163], v[56:71]
    s_add_u32 m0, s41, 16384
    ds_read_b128 v[172:175], v25 offset:49152
    ds_read_b64_tr_b16 v[44:45], v32 offset:59392
    ds_read_b64_tr_b16 v[46:47], v32 offset:59904
    buffer_load_dwordx4 v14, s[8:11], s23 offen offset:0 lds
    s_waitcnt lgkmcnt(6)
    v_mfma_f32_32x32x16_bf16 v[56:71], v[52:55], v[164:167], v[56:71]
    ds_read_b128 v[176:179], v26 offset:49152
    ds_read_b64_tr_b16 v[48:49], v32 offset:61440
    ds_read_b64_tr_b16 v[50:51], v32 offset:61952
    buffer_load_dwordx4 v15, s[8:11], s23 offen offset:1024 lds
    s_waitcnt lgkmcnt(6)
    v_mfma_f32_32x32x16_bf16 v[56:71], v[40:43], v[168:171], v[56:71]
    s_add_u32 m0, s41, 24576
    ds_read_b128 v[180:183], v27 offset:49152
    ds_read_b64_tr_b16 v[52:53], v32 offset:63488
    ds_read_b64_tr_b16 v[54:55], v32 offset:64000
    buffer_load_dwordx4 v14, s[8:11], s24 offen offset:0 lds
    s_waitcnt lgkmcnt(6)
    v_mfma_f32_32x32x16_bf16 v[56:71], v[44:47], v[172:175], v[56:71]
    s_nop 0
    buffer_load_dwordx4 v15, s[8:11], s24 offen offset:1024 lds
    s_waitcnt vmcnt(8) lgkmcnt(0)
    s_barrier
    ds_read_b128 v[184:187], v28 offset:0
    ds_read_b64_tr_b16 v[40:41], v33 offset:8192
    ds_read_b64_tr_b16 v[42:43], v33 offset:8704
    v_mfma_f32_32x32x16_bf16 v[56:71], v[48:51], v[176:179], v[56:71]
    s_add_u32 m0, s41, 32768
    ds_read_b128 v[188:191], v29 offset:0
    ds_read_b64_tr_b16 v[44:45], v33 offset:10240
    ds_read_b64_tr_b16 v[46:47], v33 offset:10752
    buffer_load_dwordx4 v14, s[8:11], s25 offen offset:0 lds
    v_mfma_f32_32x32x16_bf16 v[56:71], v[52:55], v[180:183], v[56:71]
    ds_read_b128 v[192:195], v30 offset:0
    ds_read_b64_tr_b16 v[48:49], v33 offset:12288
    ds_read_b64_tr_b16 v[50:51], v33 offset:12800
    buffer_load_dwordx4 v15, s[8:11], s25 offen offset:1024 lds
    s_waitcnt lgkmcnt(6)
    v_mfma_f32_32x32x16_bf16 v[56:71], v[40:43], v[184:187], v[56:71]
    s_add_u32 m0, s41, 40960
    ds_read_b128 v[196:199], v31 offset:0
    ds_read_b64_tr_b16 v[52:53], v33 offset:14336
    ds_read_b64_tr_b16 v[54:55], v33 offset:14848
    buffer_load_dwordx4 v14, s[8:11], s26 offen offset:0 lds
    s_waitcnt lgkmcnt(6)
    v_mfma_f32_32x32x16_bf16 v[56:71], v[44:47], v[188:191], v[56:71]
    ds_read_b128 v[200:203], v28 offset:16384
    ds_read_b64_tr_b16 v[40:41], v33 offset:24576
    ds_read_b64_tr_b16 v[42:43], v33 offset:25088
    buffer_load_dwordx4 v15, s[8:11], s26 offen offset:1024 lds
    s_waitcnt lgkmcnt(6)
    v_mfma_f32_32x32x16_bf16 v[56:71], v[48:51], v[192:195], v[56:71]
    s_add_u32 m0, s41, 49152
    ds_read_b128 v[204:207], v29 offset:16384
    ds_read_b64_tr_b16 v[44:45], v33 offset:26624
    ds_read_b64_tr_b16 v[46:47], v33 offset:27136
    buffer_load_dwordx4 v14, s[8:11], s27 offen offset:0 lds
    s_waitcnt lgkmcnt(6)
    v_mfma_f32_32x32x16_bf16 v[56:71], v[52:55], v[196:199], v[56:71]
    ds_read_b128 v[208:211], v30 offset:16384
    ds_read_b64_tr_b16 v[48:49], v33 offset:28672
    ds_read_b64_tr_b16 v[50:51], v33 offset:29184
    buffer_load_dwordx4 v15, s[8:11], s27 offen offset:1024 lds
    s_waitcnt lgkmcnt(6)
    v_mfma_f32_32x32x16_bf16 v[56:71], v[40:43], v[200:203], v[56:71]
    s_add_u32 m0, s41, 57344
    ds_read_b128 v[212:215], v31 offset:16384
    ds_read_b64_tr_b16 v[52:53], v33 offset:30720
    ds_read_b64_tr_b16 v[54:55], v33 offset:31232
    buffer_load_dwordx4 v14, s[8:11], s32 offen offset:0 lds
    s_waitcnt lgkmcnt(6)
    v_mfma_f32_32x32x16_bf16 v[56:71], v[44:47], v[204:207], v[56:71]
    s_nop 0
    buffer_load_dwordx4 v15, s[8:11], s32 offen offset:1024 lds
    s_waitcnt vmcnt(8) lgkmcnt(0)
    s_barrier
    ds_read_b128 v[216:219], v24 offset:0
    ds_read_b64_tr_b16 v[40:41], v32 offset:8192
    ds_read_b64_tr_b16 v[42:43], v32 offset:8704
    v_mfma_f32_32x32x16_bf16 v[56:71], v[48:51], v[208:211], v[56:71]
    s_add_u32 m0, s41, 65536
    ds_read_b128 v[220:223], v25 offset:0
    ds_read_b64_tr_b16 v[44:45], v32 offset:10240
    ds_read_b64_tr_b16 v[46:47], v32 offset:10752
    buffer_load_dwordx4 v14, s[8:11], s33 offen offset:0 lds
    v_mfma_f32_32x32x16_bf16 v[56:71], v[52:55], v[212:215], v[56:71]
    ds_read_b128 v[224:227], v26 offset:0
    ds_read_b64_tr_b16 v[48:49], v32 offset:12288
    ds_read_b64_tr_b16 v[50:51], v32 offset:12800
    buffer_load_dwordx4 v15, s[8:11], s33 offen offset:1024 lds
    s_waitcnt lgkmcnt(6)
    v_mfma_f32_32x32x16_bf16 v[56:71], v[40:43], v[216:219], v[56:71]
    s_add_u32 m0, s41, 73728
    ds_read_b128 v[228:231], v27 offset:0
    ds_read_b64_tr_b16 v[52:53], v32 offset:14336
    ds_read_b64_tr_b16 v[54:55], v32 offset:14848
    buffer_load_dwordx4 v16, s[8:11], s23 offen offset:0 lds
    s_waitcnt lgkmcnt(6)
    v_mfma_f32_32x32x16_bf16 v[56:71], v[44:47], v[220:223], v[56:71]
    ds_read_b64_tr_b16 v[40:41], v32 offset:16384
    ds_read_b64_tr_b16 v[42:43], v32 offset:16896
    buffer_load_dwordx4 v17, s[8:11], s23 offen offset:1024 lds
    s_waitcnt lgkmcnt(5)
    v_mfma_f32_32x32x16_bf16 v[56:71], v[48:51], v[224:227], v[56:71]
    s_add_u32 m0, s41, 81920
    ds_read_b64_tr_b16 v[44:45], v32 offset:18432
    ds_read_b64_tr_b16 v[46:47], v32 offset:18944
    buffer_load_dwordx4 v16, s[8:11], s24 offen offset:0 lds
    s_waitcnt lgkmcnt(4)
    v_mfma_f32_32x32x16_bf16 v[56:71], v[52:55], v[228:231], v[56:71]
    ds_read_b64_tr_b16 v[48:49], v32 offset:20480
    ds_read_b64_tr_b16 v[50:51], v32 offset:20992
    buffer_load_dwordx4 v17, s[8:11], s24 offen offset:1024 lds
    s_waitcnt lgkmcnt(4)
    v_mfma_f32_32x32x16_bf16 v[72:87], v[120:123], v[40:43], 0
    s_add_u32 m0, s41, 90112
    ds_read_b64_tr_b16 v[52:53], v32 offset:22528
    ds_read_b64_tr_b16 v[54:55], v32 offset:23040
    buffer_load_dwordx4 v16, s[8:11], s25 offen offset:0 lds
    s_waitcnt lgkmcnt(4)
    v_mfma_f32_32x32x16_bf16 v[72:87], v[124:127], v[44:47], v[72:87]
    ds_read_b64_tr_b16 v[40:41], v32 offset:24576
    ds_read_b64_tr_b16 v[42:43], v32 offset:25088
    buffer_load_dwordx4 v17, s[8:11], s25 offen offset:1024 lds
    s_waitcnt lgkmcnt(4)
    v_mfma_f32_32x32x16_bf16 v[72:87], v[128:131], v[48:51], v[72:87]
    ds_read_b64_tr_b16 v[44:45], v32 offset:26624
    ds_read_b64_tr_b16 v[46:47], v32 offset:27136
    s_waitcnt lgkmcnt(4)
    v_mfma_f32_32x32x16_bf16 v[72:87], v[132:135], v[52:55], v[72:87]
    ds_read_b64_tr_b16 v[48:49], v32 offset:28672
    ds_read_b64_tr_b16 v[50:51], v32 offset:29184
    v_cvt_pk_bf16_f32 v56, v56, v57
    v_cvt_pk_bf16_f32 v57, v58, v59
    v_cvt_pk_bf16_f32 v58, v60, v61
    s_waitcnt lgkmcnt(4)
    v_mfma_f32_32x32x16_bf16 v[72:87], v[136:139], v[40:43], v[72:87]
    ds_read_b64_tr_b16 v[52:53], v32 offset:30720
    ds_read_b64_tr_b16 v[54:55], v32 offset:31232
    v_cvt_pk_bf16_f32 v59, v62, v63
    v_cvt_pk_bf16_f32 v60, v64, v65
    v_cvt_pk_bf16_f32 v61, v66, v67
    s_waitcnt lgkmcnt(4)
    v_mfma_f32_32x32x16_bf16 v[72:87], v[140:143], v[44:47], v[72:87]
    s_waitcnt vmcnt(8) lgkmcnt(0)
    s_barrier
    ds_read_b64_tr_b16 v[40:41], v32 offset:32768
    ds_read_b64_tr_b16 v[42:43], v32 offset:33280
    v_cvt_pk_bf16_f32 v62, v68, v69
    v_cvt_pk_bf16_f32 v63, v70, v71
    v_permlane32_swap_b32 v56, v58
    v_mfma_f32_32x32x16_bf16 v[72:87], v[144:147], v[48:51], v[72:87]
    s_add_u32 m0, s41, 0
    ds_read_b64_tr_b16 v[44:45], v32 offset:34816
    ds_read_b64_tr_b16 v[46:47], v32 offset:35328
    buffer_load_dwordx4 v16, s[8:11], s26 offen offset:0 lds
    v_permlane32_swap_b32 v57, v59
    v_permlane32_swap_b32 v60, v62
    v_permlane32_swap_b32 v61, v63
    v_mfma_f32_32x32x16_bf16 v[72:87], v[148:151], v[52:55], v[72:87]
    ds_read_b64_tr_b16 v[48:49], v32 offset:36864
    ds_read_b64_tr_b16 v[50:51], v32 offset:37376
    buffer_load_dwordx4 v17, s[8:11], s26 offen offset:1024 lds
    s_waitcnt lgkmcnt(4)
    v_mfma_f32_32x32x16_bf16 v[72:87], v[152:155], v[40:43], v[72:87]
    s_add_u32 m0, s41, 8192
    ds_read_b64_tr_b16 v[52:53], v32 offset:38912
    ds_read_b64_tr_b16 v[54:55], v32 offset:39424
    buffer_load_dwordx4 v16, s[8:11], s27 offen offset:0 lds
    s_waitcnt lgkmcnt(4)
    v_mfma_f32_32x32x16_bf16 v[72:87], v[156:159], v[44:47], v[72:87]
    ds_read_b64_tr_b16 v[40:41], v32 offset:40960
    ds_read_b64_tr_b16 v[42:43], v32 offset:41472
    buffer_load_dwordx4 v17, s[8:11], s27 offen offset:1024 lds
    s_waitcnt lgkmcnt(4)
    v_mfma_f32_32x32x16_bf16 v[72:87], v[160:163], v[48:51], v[72:87]
    s_add_u32 m0, s41, 16384
    ds_read_b64_tr_b16 v[44:45], v32 offset:43008
    ds_read_b64_tr_b16 v[46:47], v32 offset:43520
    buffer_load_dwordx4 v16, s[8:11], s32 offen offset:0 lds
    s_waitcnt lgkmcnt(4)
    v_mfma_f32_32x32x16_bf16 v[72:87], v[164:167], v[52:55], v[72:87]
    ds_read_b64_tr_b16 v[48:49], v32 offset:45056
    ds_read_b64_tr_b16 v[50:51], v32 offset:45568
    buffer_load_dwordx4 v17, s[8:11], s32 offen offset:1024 lds
    s_waitcnt lgkmcnt(4)
    v_mfma_f32_32x32x16_bf16 v[72:87], v[168:171], v[40:43], v[72:87]
    s_add_u32 m0, s41, 24576
    ds_read_b64_tr_b16 v[52:53], v32 offset:47104
    ds_read_b64_tr_b16 v[54:55], v32 offset:47616
    buffer_load_dwordx4 v16, s[8:11], s33 offen offset:0 lds
    s_waitcnt lgkmcnt(4)
    v_mfma_f32_32x32x16_bf16 v[72:87], v[172:175], v[44:47], v[72:87]
    ds_read_b64_tr_b16 v[40:41], v32 offset:49152
    ds_read_b64_tr_b16 v[42:43], v32 offset:49664
    buffer_load_dwordx4 v17, s[8:11], s33 offen offset:1024 lds
    global_load_dwordx2 v[8:9], v10, s[48:49] sc1
    s_waitcnt lgkmcnt(4)
    v_mfma_f32_32x32x16_bf16 v[72:87], v[176:179], v[48:51], v[72:87]
    ds_read_b64_tr_b16 v[44:45], v32 offset:51200
    ds_read_b64_tr_b16 v[46:47], v32 offset:51712
    s_waitcnt lgkmcnt(4)
    v_mfma_f32_32x32x16_bf16 v[72:87], v[180:183], v[52:55], v[72:87]
    ds_read_b64_tr_b16 v[48:49], v32 offset:53248
    ds_read_b64_tr_b16 v[50:51], v32 offset:53760
    s_waitcnt lgkmcnt(4)
    v_mfma_f32_32x32x16_bf16 v[72:87], v[184:187], v[40:43], v[72:87]
    ds_read_b64_tr_b16 v[52:53], v32 offset:55296
    ds_read_b64_tr_b16 v[54:55], v32 offset:55808
    s_waitcnt lgkmcnt(4)
    v_mfma_f32_32x32x16_bf16 v[72:87], v[188:191], v[44:47], v[72:87]
    ds_read_b64_tr_b16 v[40:41], v32 offset:57344
    ds_read_b64_tr_b16 v[42:43], v32 offset:57856
    s_waitcnt lgkmcnt(4)
    v_mfma_f32_32x32x16_bf16 v[72:87], v[192:195], v[48:51], v[72:87]
    ds_read_b64_tr_b16 v[44:45], v32 offset:59392
    ds_read_b64_tr_b16 v[46:47], v32 offset:59904
    s_waitcnt lgkmcnt(4)
    v_mfma_f32_32x32x16_bf16 v[72:87], v[196:199], v[52:55], v[72:87]
    ds_read_b64_tr_b16 v[48:49], v32 offset:61440
    ds_read_b64_tr_b16 v[50:51], v32 offset:61952
    s_waitcnt lgkmcnt(4)
    v_mfma_f32_32x32x16_bf16 v[72:87], v[200:203], v[40:43], v[72:87]
    ds_read_b64_tr_b16 v[52:53], v32 offset:63488
    ds_read_b64_tr_b16 v[54:55], v32 offset:64000
    s_waitcnt lgkmcnt(4)
    v_mfma_f32_32x32x16_bf16 v[72:87], v[204:207], v[44:47], v[72:87]
    s_waitcnt vmcnt(9) lgkmcnt(0)
    s_barrier
    ds_read_b64_tr_b16 v[40:41], v33 offset:0
    ds_read_b64_tr_b16 v[42:43], v33 offset:512
    buffer_store_dwordx4 v[56:59], v34, s[12:15], s28 offen offset:0 sc1
    buffer_store_dwordx4 v[60:63], v35, s[12:15], s28 offen offset:1024 sc1
    v_mfma_f32_32x32x16_bf16 v[72:87], v[208:211], v[48:51], v[72:87]
    ds_read_b64_tr_b16 v[44:45], v33 offset:2048
    ds_read_b64_tr_b16 v[46:47], v33 offset:2560
    v_mfma_f32_32x32x16_bf16 v[72:87], v[212:215], v[52:55], v[72:87]
    ds_read_b64_tr_b16 v[48:49], v33 offset:4096
    ds_read_b64_tr_b16 v[50:51], v33 offset:4608
    s_waitcnt lgkmcnt(4)
    v_mfma_f32_32x32x16_bf16 v[72:87], v[216:219], v[40:43], v[72:87]
    ds_read_b64_tr_b16 v[52:53], v33 offset:6144
    ds_read_b64_tr_b16 v[54:55], v33 offset:6656
    s_waitcnt lgkmcnt(4)
    v_mfma_f32_32x32x16_bf16 v[72:87], v[220:223], v[44:47], v[72:87]
    ds_read_b64_tr_b16 v[40:41], v33 offset:8192
    ds_read_b64_tr_b16 v[42:43], v33 offset:8704
    s_waitcnt lgkmcnt(4)
    v_mfma_f32_32x32x16_bf16 v[72:87], v[224:227], v[48:51], v[72:87]
    ds_read_b64_tr_b16 v[44:45], v33 offset:10240
    ds_read_b64_tr_b16 v[46:47], v33 offset:10752
    s_waitcnt lgkmcnt(4)
    v_mfma_f32_32x32x16_bf16 v[72:87], v[228:231], v[52:55], v[72:87]
    ds_read_b64_tr_b16 v[48:49], v33 offset:12288
    ds_read_b64_tr_b16 v[50:51], v33 offset:12800
G_q:
    s_waitcnt lgkmcnt(4)
    v_mfma_f32_32x32x16_bf16 v[88:103], v[40:43], v[120:123], 0
    ds_read_b64_tr_b16 v[52:53], v33 offset:14336
    ds_read_b64_tr_b16 v[54:55], v33 offset:14848
    s_waitcnt lgkmcnt(4)
    v_mfma_f32_32x32x16_bf16 v[88:103], v[44:47], v[124:127], v[88:103]
    ds_read_b64_tr_b16 v[40:41], v33 offset:16384
    ds_read_b64_tr_b16 v[42:43], v33 offset:16896
    s_waitcnt lgkmcnt(4)
    v_mfma_f32_32x32x16_bf16 v[88:103], v[48:51], v[128:131], v[88:103]
    ds_read_b64_tr_b16 v[44:45], v33 offset:18432
    ds_read_b64_tr_b16 v[46:47], v33 offset:18944
    s_waitcnt lgkmcnt(4)
    v_mfma_f32_32x32x16_bf16 v[88:103], v[52:55], v[132:135], v[88:103]
    ds_read_b64_tr_b16 v[48:49], v33 offset:20480
    ds_read_b64_tr_b16 v[50:51], v33 offset:20992
    v_cvt_pk_bf16_f32 v72, v72, v73
    v_cvt_pk_bf16_f32 v73, v74, v75
    v_cvt_pk_bf16_f32 v74, v76, v77
    s_waitcnt lgkmcnt(4)
    v_mfma_f32_32x32x16_bf16 v[88:103], v[40:43], v[136:139], v[88:103]
    ds_read_b64_tr_b16 v[52:53], v33 offset:22528
    ds_read_b64_tr_b16 v[54:55], v33 offset:23040
    v_cvt_pk_bf16_f32 v75, v78, v79
    v_cvt_pk_bf16_f32 v76, v80, v81
    v_cvt_pk_bf16_f32 v77, v82, v83
    s_waitcnt lgkmcnt(4)
    v_mfma_f32_32x32x16_bf16 v[88:103], v[44:47], v[140:143], v[88:103]
    ds_read_b64_tr_b16 v[40:41], v33 offset:24576
    ds_read_b64_tr_b16 v[42:43], v33 offset:25088
    v_cvt_pk_bf16_f32 v78, v84, v85
    v_cvt_pk_bf16_f32 v79, v86, v87
    v_permlane32_swap_b32 v72, v74
    s_waitcnt lgkmcnt(4)
    v_mfma_f32_32x32x16_bf16 v[88:103], v[48:51], v[144:147], v[88:103]
    ds_read_b64_tr_b16 v[44:45], v33 offset:26624
    ds_read_b64_tr_b16 v[46:47], v33 offset:27136
    v_permlane32_swap_b32 v73, v75
    v_permlane32_swap_b32 v76, v78
    v_permlane32_swap_b32 v77, v79
    s_waitcnt lgkmcnt(4)
    v_mfma_f32_32x32x16_bf16 v[88:103], v[52:55], v[148:151], v[88:103]
    ds_read_b64_tr_b16 v[48:49], v33 offset:28672
    ds_read_b64_tr_b16 v[50:51], v33 offset:29184
    buffer_store_dwordx4 v[72:75], v34, s[12:15], s29 offen offset:0 sc1
    buffer_store_dwordx4 v[76:79], v35, s[12:15], s29 offen offset:1024 sc1
    s_waitcnt lgkmcnt(4)
    v_mfma_f32_32x32x16_bf16 v[88:103], v[40:43], v[152:155], v[88:103]
    ds_read_b64_tr_b16 v[52:53], v33 offset:30720
    ds_read_b64_tr_b16 v[54:55], v33 offset:31232
    s_waitcnt lgkmcnt(4)
    v_mfma_f32_32x32x16_bf16 v[88:103], v[44:47], v[156:159], v[88:103]
    s_waitcnt vmcnt(5) lgkmcnt(0)
    s_barrier
    ds_read_b64_tr_b16 v[40:41], v32 offset:0
    ds_read_b64_tr_b16 v[42:43], v32 offset:512
    v_mfma_f32_32x32x16_bf16 v[88:103], v[48:51], v[160:163], v[88:103]
    ds_read_b64_tr_b16 v[44:45], v32 offset:2048
    ds_read_b64_tr_b16 v[46:47], v32 offset:2560
    v_mfma_f32_32x32x16_bf16 v[88:103], v[52:55], v[164:167], v[88:103]
    ds_read_b64_tr_b16 v[48:49], v32 offset:4096
    ds_read_b64_tr_b16 v[50:51], v32 offset:4608
    s_waitcnt lgkmcnt(4)
    v_mfma_f32_32x32x16_bf16 v[88:103], v[40:43], v[168:171], v[88:103]
    ds_read_b64_tr_b16 v[52:53], v32 offset:6144
    ds_read_b64_tr_b16 v[54:55], v32 offset:6656
    s_waitcnt lgkmcnt(4)
    v_mfma_f32_32x32x16_bf16 v[88:103], v[44:47], v[172:175], v[88:103]
    ds_read_b64_tr_b16 v[40:41], v32 offset:8192
    ds_read_b64_tr_b16 v[42:43], v32 offset:8704
    s_waitcnt lgkmcnt(4)
    v_mfma_f32_32x32x16_bf16 v[88:103], v[48:51], v[176:179], v[88:103]
    ds_read_b64_tr_b16 v[44:45], v32 offset:10240
    ds_read_b64_tr_b16 v[46:47], v32 offset:10752
    s_waitcnt lgkmcnt(4)
    v_mfma_f32_32x32x16_bf16 v[88:103], v[52:55], v[180:183], v[88:103]
    ds_read_b64_tr_b16 v[48:49], v32 offset:12288
    ds_read_b64_tr_b16 v[50:51], v32 offset:12800
    s_waitcnt lgkmcnt(4)
    v_mfma_f32_32x32x16_bf16 v[88:103], v[40:43], v[184:187], v[88:103]
    ds_read_b64_tr_b16 v[52:53], v32 offset:14336
    ds_read_b64_tr_b16 v[54:55], v32 offset:14848
    s_waitcnt lgkmcnt(4)
    v_mfma_f32_32x32x16_bf16 v[88:103], v[44:47], v[188:191], v[88:103]
    ds_read_b64_tr_b16 v[40:41], v32 offset:16384
    ds_read_b64_tr_b16 v[42:43], v32 offset:16896
    s_waitcnt lgkmcnt(4)
    v_mfma_f32_32x32x16_bf16 v[88:103], v[48:51], v[192:195], v[88:103]
    ds_read_b64_tr_b16 v[44:45], v32 offset:18432
    ds_read_b64_tr_b16 v[46:47], v32 offset:18944
    s_waitcnt lgkmcnt(4)
    v_mfma_f32_32x32x16_bf16 v[88:103], v[52:55], v[196:199], v[88:103]
    ds_read_b64_tr_b16 v[48:49], v32 offset:20480
    ds_read_b64_tr_b16 v[50:51], v32 offset:20992
    s_waitcnt lgkmcnt(4)
    v_mfma_f32_32x32x16_bf16 v[88:103], v[40:43], v[200:203], v[88:103]
    ds_read_b64_tr_b16 v[52:53], v32 offset:22528
    ds_read_b64_tr_b16 v[54:55], v32 offset:23040
    s_waitcnt lgkmcnt(4)
    v_mfma_f32_32x32x16_bf16 v[88:103], v[44:47], v[204:207], v[88:103]
    ds_read_b64_tr_b16 v[40:41], v32 offset:24576
    ds_read_b64_tr_b16 v[42:43], v32 offset:25088
    s_waitcnt lgkmcnt(4)
    v_mfma_f32_32x32x16_bf16 v[88:103], v[48:51], v[208:211], v[88:103]
    ds_read_b64_tr_b16 v[44:45], v32 offset:26624
    ds_read_b64_tr_b16 v[46:47], v32 offset:27136
    s_waitcnt lgkmcnt(4)
    v_mfma_f32_32x32x16_bf16 v[88:103], v[52:55], v[212:215], v[88:103]
    ds_read_b64_tr_b16 v[48:49], v32 offset:28672
    ds_read_b64_tr_b16 v[50:51], v32 offset:29184
    s_waitcnt lgkmcnt(4)
    v_mfma_f32_32x32x16_bf16 v[88:103], v[40:43], v[216:219], v[88:103]
    ds_read_b64_tr_b16 v[52:53], v32 offset:30720
    ds_read_b64_tr_b16 v[54:55], v32 offset:31232
    s_waitcnt lgkmcnt(4)
    v_mfma_f32_32x32x16_bf16 v[88:103], v[44:47], v[220:223], v[88:103]
    s_waitcnt lgkmcnt(2)
    v_mfma_f32_32x32x16_bf16 v[88:103], v[48:51], v[224:227], v[88:103]
    s_waitcnt lgkmcnt(0)
    v_mfma_f32_32x32x16_bf16 v[88:103], v[52:55], v[228:231], v[88:103]
    s_waitcnt vmcnt(4)
    s_mov_b32 s60, 0
A_tok:
    v_readfirstlane_b32 s62, v8
    v_readfirstlane_b32 s63, v9
    s_cmp_lg_u64 s[62:63], 0
    s_cbranch_scc1 A_tok_ok
    global_load_dwordx2 v[8:9], v10, s[48:49] sc1
    s_add_u32 s60, s60, 1
    s_cmp_gt_u32 s60, 400000
    s_cbranch_scc1 L_end
    s_waitcnt vmcnt(0)
    s_branch A_tok
A_tok_ok:
    s_nop 5
    s_nop 0
    v_pk_mul_f32 v[88:89], v[88:89], s[30:31] op_sel_hi:[1,0]
    v_pk_mul_f32 v[90:91], v[90:91], s[30:31] op_sel_hi:[1,0]
    v_pk_mul_f32 v[92:93], v[92:93], s[30:31] op_sel_hi:[1,0]
    v_pk_mul_f32 v[94:95], v[94:95], s[30:31] op_sel_hi:[1,0]
    v_pk_mul_f32 v[96:97], v[96:97], s[30:31] op_sel_hi:[1,0]
    v_pk_mul_f32 v[98:99], v[98:99], s[30:31] op_sel_hi:[1,0]
    v_pk_mul_f32 v[100:101], v[100:101], s[30:31] op_sel_hi:[1,0]
    v_pk_mul_f32 v[102:103], v[102:103], s[30:31] op_sel_hi:[1,0]
G_noscale:
    v_cvt_pk_bf16_f32 v88, v88, v89
    v_cvt_pk_bf16_f32 v89, v90, v91
    v_cvt_pk_bf16_f32 v90, v92, v93
    v_cvt_pk_bf16_f32 v91, v94, v95
    v_cvt_pk_bf16_f32 v92, v96, v97
    v_cvt_pk_bf16_f32 v93, v98, v99
    v_cvt_pk_bf16_f32 v94, v100, v101
    v_cvt_pk_bf16_f32 v95, v102, v103
    v_permlane32_swap_b32 v88, v90
    v_permlane32_swap_b32 v89, v91
    v_permlane32_swap_b32 v92, v94
    v_permlane32_swap_b32 v93, v95
    buffer_store_dwordx4 v[88:91], v34, s[12:15], s42 offen offset:0 sc1
    buffer_store_dwordx4 v[92:95], v35, s[12:15], s42 offen offset:1024 sc1
L_attn:
    v_mov_b64 v[224:225], 0
    v_mov_b64 v[226:227], 0
    v_mov_b64 v[228:229], 0
    v_mov_b64 v[230:231], 0
    v_mov_b32 v32, 0xdddddddd
    s_mov_b64 exec, 0xffff
    v_add_u32 v17, 122880, v1
    ds_write_b128 v17, v[224:227]
    s_mov_b64 exec, -1
    v_mfma_f32_32x32x16_bf16 v[104:119], v[224:227], v[224:227], 0
    v_mov_b64 v[40:41], 0
    v_mov_b64 v[46:47], 0
    v_mov_b64 v[24:25], v[232:233]
    v_mfma_f32_32x32x16_bf16 v[120:135], v[224:227], v[224:227], 0
    v_mov_b64 v[48:49], 0
    v_mov_b64 v[54:55], 0
    v_mov_b64 v[26:27], v[232:233]
    v_mfma_f32_32x32x16_bf16 v[136:151], v[224:227], v[224:227], 0
    v_mov_b64 v[56:57], 0
    v_mov_b64 v[62:63], 0
    v_mov_b64 v[28:29], v[232:233]
    v_mfma_f32_32x32x16_bf16 v[152:167], v[224:227], v[224:227], 0
    v_mov_b64 v[64:65], 0
    v_mov_b64 v[70:71], 0
    v_mov_b64 v[30:31], v[232:233]
    s_mov_b32 s60, 0
A_role:
    ds_read_b32 v16, v10 offset:61448
    s_add_u32 s60, s60, 1
    s_cmp_gt_u32 s60, 3200000
    s_cbranch_scc1 L_end
    s_waitcnt lgkmcnt(0)
    v_readfirstlane_b32 s69, v16
    s_cmp_eq_u32 s69, 0
    s_cbranch_scc1 A_role
    s_sub_u32 s69, s69, 1
    s_and_b32 s36, s69, 15
    s_and_b32 s39, s69, 1
    s_lshr_b32 s37, s69, 4
    s_mul_i32 s38, s36, 7
    s_lshr_b32 s38, s38, 1
    v_lshlrev_b32 v16, 4, v2
    v_add_u32 v17, s38, v3
    v_and_b32 v17, 3, v17
    v_lshlrev_b32 v17, 6, v17
    v_xor_b32 v17, v17, v16
    v_lshl_add_u32 v4, v3, 9, v17
    v_xor_b32 v5, 128, v4
    s_mul_i32 s41, s36, 28
    s_add_u32 s41, s41, 896
    v_add_u32 v16, s41, v2
    v_and_b32 v17, 31, v16
    v_lshlrev_b32 v17, 4, v17
    v_mul_u32_u24 v18, 576, v3
    v_xor_b32 v17, v17, v18
    v_lshrrev_b32 v16, 5, v16
    v_lshl_add_u32 v16, v16, 11, v17
    s_add_u32 s41, s38, 56
    s_lshl_b32 s41, s41, 9
    v_xor_b32 v17, 128, v16
    v_subrev_u32 v12, s41, v16
    v_subrev_u32 v13, s41, v17
    s_mov_b32 s30, 0x0fffffff
    s_mov_b32 s31, s30
    s_mul_i32 s28, s3, 1376256
    s_add_u32 s28, s28, s41
    s_add_u32 s17, s28, 1376256
    s_and_b32 s16, s68, 3
    s_mul_i32 s16, s16, 344064
    s_add_u32 s16, s16, s28
    s_mul_i32 s40, s3, 9472
    s_add_u32 s40, s40, 123136
    s_lshl_b32 s41, s3, 3
    v_and_b32 v17, 7, v0
    v_add_u32 v17, s41, v17
    s_lshl_b32 s41, s37, 1
    s_mov_b32 exec_lo, 0
    v_and_b32 v17, 1, v0
    v_add_u32 v17, s41, v17
    s_mov_b32 exec_lo, -1
    v_bfe_u32 v18, v0, 3, 1
    v_mad_u32_u24 v16, v18, 3, s38
    v_lshrrev_b32 v16, 3, v16
    v_lshl_add_u32 v16, v16, 5, v17
    v_lshlrev_b32 v16, 7, v16
    s_lshl2_add_u32 s42, s37, s3
    s_lshl4_add_u32 s42, s42, s36
    s_lshl_b32 s42, s42, 11
    s_add_u32 s42, s42, 11534336
    s_lshl2_add_u32 s21, s69, s3
    s_lshl_b32 s21, s21, 7
    s_add_u32 s21, s21, 14155776
    v_mov_b32 v14, s21
    s_mov_b64 exec, 0xffff
    v_lshl_add_u32 v14, v0, 7, s42
    s_mov_b64 exec, -1
    s_lshl_b32 s20, s38, 9
    s_lshl_b32 s22, s68, 15
    s_add_u32 s22, s22, 13631488
    s_add_u32 s41, s3, 1
    s_and_b32 s41, s41, 3
    s_mul_i32 s23, s41, 12288
    v_add_u32 v20, s23, v1
    s_lshl2_add_u32 s41, s37, s41
    s_mul_i32 s41, s41, 86016
    s_add_u32 s24, s41, s20
    s_add_u32 s41, s3, 2
    s_and_b32 s41, s41, 3
    s_mul_i32 s23, s41, 12288
    v_add_u32 v21, s23, v1
    s_lshl2_add_u32 s41, s37, s41
    s_mul_i32 s41, s41, 86016
    s_add_u32 s25, s41, s20
    s_add_u32 s41, s3, 3
    s_and_b32 s41, s41, 3
    s_mul_i32 s23, s41, 12288
    v_add_u32 v22, s23, v1
    s_lshl2_add_u32 s41, s37, s41
    s_mul_i32 s41, s41, 86016
    s_add_u32 s26, s41, s20
    s_add_u32 s41, s3, 4
    s_and_b32 s41, s41, 3
    s_lshl2_add_u32 s41, s37, s41
    s_mul_i32 s41, s41, 86016
    s_add_u32 s27, s41, s20
    s_cmp_eq_u32 s34, 7
    s_cbranch_scc1 A_go
    v_mov_b32 v17, 1
    s_waitcnt vmcnt(0)
    s_mov_b64 exec, 1
    ds_add_rtn_u32 v17, v10, v17 offset:61440
    s_mov_b64 exec, -1
    s_add_u32 s41, s61, 13631488
    s_waitcnt lgkmcnt(0)
    v_readfirstlane_b32 s23, v17
    s_cmp_lg_u32 s23, 3
    s_cbranch_scc1 A_nopub
    v_lshlrev_b32 v17, 15, v0
    s_mov_b64 exec, 0xff
    buffer_store_dwordx2 v[8:9], v17, s[12:15], s41 offen sc1
    s_mov_b64 exec, -1
A_nopub:
    s_setprio 0
    s_mov_b32 s60, 0
A_a2:
    ds_read_b32 v17, v10 offset:61472
    s_add_u32 s60, s60, 1
    s_cmp_gt_u32 s60, 3200000
    s_cbranch_scc1 L_end
    s_waitcnt lgkmcnt(0)
    v_cmp_ne_u32 vcc, 1, v17
    s_cbranch_vccnz A_a2
A_go:
    s_mov_b32 s43, 0
    s_waitcnt lgkmcnt(0)
    s_mov_b32 s60, 0
    s_mov_b32 exec_lo, 0xffff
    s_mov_b32 exec_hi, 0x303
A_spin:
    buffer_load_dwordx2 v[18:19], v16, s[12:15], s22 offen sc1
    s_add_u32 s60, s60, 1
    s_cmp_gt_u32 s60, 400000
    s_cbranch_scc1 L_end
    s_waitcnt vmcnt(0)
    v_cmp_ne_u64 vcc, v[18:19], s[62:63]
    s_and_b64 exec, exec, vcc
    s_cbranch_scc1 A_spin
    s_mov_b64 exec, -1
    buffer_load_dwordx4 v[168:171], v4, s[12:15], s16 offen offset:0 sc1
    buffer_load_dwordx4 v[172:175], v5, s[12:15], s16 offen offset:1024 sc1
    s_cmp_eq_u32 s39, 0
    s_cbranch_scc0 A_odd
    buffer_load_dwordx4 v[40:43], v4, s[12:15], s24 offen offset:0 sc1
    s_mov_b32 exec_hi, 0
    buffer_load_dwordx4 v[44:47], v5, s[12:15], s24 offen offset:1024 sc1
    s_not_b64 exec, exec
    buffer_load_dwordx2 v[44:45], v5, s[12:15], s24 offen offset:1024 sc1
    s_mov_b32 exec_lo, -1
    buffer_load_dwordx4 v[48:51], v4, s[12:15], s25 offen offset:0 sc1
    s_mov_b32 exec_hi, 0
    buffer_load_dwordx4 v[52:55], v5, s[12:15], s25 offen offset:1024 sc1
    s_not_b64 exec, exec
    buffer_load_dwordx2 v[52:53], v5, s[12:15], s25 offen offset:1024 sc1
    s_mov_b32 exec_lo, -1
    s_mov_b64 exec, s[30:31]
    buffer_load_dwordx4 v[24:27], v12, s[12:15], s16 offen offset:0 sc1
    buffer_load_dwordx4 v[28:31], v13, s[12:15], s16 offen offset:1024 sc1
    s_mov_b64 exec, -1
    buffer_load_dwordx4 v[56:59], v4, s[12:15], s26 offen offset:0 sc1
    s_mov_b32 exec_hi, 0
    buffer_load_dwordx4 v[60:63], v5, s[12:15], s26 offen offset:1024 sc1
    s_not_b64 exec, exec
    buffer_load_dwordx2 v[60:61], v5, s[12:15], s26 offen offset:1024 sc1
    s_mov_b32 exec_lo, -1
    buffer_load_dwordx4 v[64:67], v4, s[12:15], s27 offen offset:0 sc1
    s_mov_b32 exec_hi, 0
    buffer_load_dwordx4 v[68:71], v5, s[12:15], s27 offen offset:1024 sc1
    s_not_b64 exec, exec
    buffer_load_dwordx2 v[68:69], v5, s[12:15], s27 offen offset:1024 sc1
    s_mov_b32 exec_lo, -1
    s_branch A_z
A_odd:
    buffer_load_dwordx4 v[44:47], v5, s[12:15], s24 offen offset:1024 sc1
    s_mov_b32 exec_hi, 0
    buffer_load_dwordx2 v[42:43], v4, s[12:15], s24 offen offset:8 sc1
    s_not_b64 exec, exec
    buffer_load_dwordx4 v[40:43], v4, s[12:15], s24 offen offset:0 sc1
    s_mov_b32 exec_lo, -1
    buffer_load_dwordx4 v[52:55], v5, s[12:15], s25 offen offset:1024 sc1
    s_mov_b32 exec_hi, 0
    buffer_load_dwordx2 v[50:51], v4, s[12:15], s25 offen offset:8 sc1
    s_not_b64 exec, exec
    buffer_load_dwordx4 v[48:51], v4, s[12:15], s25 offen offset:0 sc1
    s_mov_b32 exec_lo, -1
    s_mov_b64 exec, s[30:31]
    buffer_load_dwordx4 v[24:27], v12, s[12:15], s16 offen offset:0 sc1
    buffer_load_dwordx4 v[28:31], v13, s[12:15], s16 offen offset:1024 sc1
    s_mov_b64 exec, -1
    buffer_load_dwordx4 v[60:63], v5, s[12:15], s26 offen offset:1024 sc1
    s_mov_b32 exec_hi, 0
    buffer_load_dwordx2 v[58:59], v4, s[12:15], s26 offen offset:8 sc1
    s_not_b64 exec, exec
    buffer_load_dwordx4 v[56:59], v4, s[12:15], s26 offen offset:0 sc1
    s_mov_b32 exec_lo, -1
    buffer_load_dwordx4 v[68:71], v5, s[12:15], s27 offen offset:1024 sc1
    s_mov_b32 exec_hi, 0
    buffer_load_dwordx2 v[66:67], v4, s[12:15], s27 offen offset:8 sc1
    s_not_b64 exec, exec
    buffer_load_dwordx4 v[64:67], v4, s[12:15], s27 offen offset:0 sc1
    s_mov_b32 exec_lo, -1
A_z:
    s_add_u32 s16, s16, 86016
    buffer_load_dwordx4 v[176:179], v4, s[12:15], s16 offen offset:0 sc1
    buffer_load_dwordx4 v[180:183], v5, s[12:15], s16 offen offset:1024 sc1
    s_mov_b64 exec, s[30:31]
    buffer_load_dwordx4 v[232:235], v12, s[12:15], s16 offen offset:0 sc1
    buffer_load_dwordx4 v[236:239], v13, s[12:15], s16 offen offset:1024 sc1
    s_mov_b64 exec, -1
    s_add_u32 s16, s16, 86016
    s_waitcnt vmcnt(15)
    s_setprio 2
    v_mfma_f32_32x32x16_bf16 v[72:87], v[168:171], v[40:43], 0
    v_mfma_f32_32x32x16_bf16 v[72:87], v[172:175], v[44:47], v[72:87]
    buffer_load_dwordx4 v[184:187], v4, s[12:15], s16 offen offset:0 sc1
    buffer_load_dwordx4 v[188:191], v5, s[12:15], s16 offen offset:1024 sc1
    s_mov_b64 exec, s[30:31]
    buffer_load_dwordx4 v[240:243], v12, s[12:15], s16 offen offset:0 sc1
    buffer_load_dwordx4 v[244:247], v13, s[12:15], s16 offen offset:1024 sc1
    s_mov_b64 exec, -1
    s_add_u32 s16, s16, 86016
    buffer_load_dwordx4 v[192:195], v4, s[12:15], s16 offen offset:0 sc1
    buffer_load_dwordx4 v[196:199], v5, s[12:15], s16 offen offset:1024 sc1
    v_mov_b32 v16, 1
    s_mov_b64 exec, 1
    ds_add_u32 v10, v16 offset:61452
    s_mov_b64 exec, -1
    s_waitcnt vmcnt(18)
.p2align 3
A_loop:
    v_exp_f32 v72, v72
    v_exp_f32 v73, v73
    v_mfma_f32_32x32x16_bf16 v[88:103], v[168:171], v[48:51], 0
    v_exp_f32 v74, v74
    v_exp_f32 v75, v75
    v_exp_f32 v76, v76
    v_exp_f32 v77, v77
    v_mfma_f32_32x32x16_bf16 v[88:103], v[172:175], v[52:55], v[88:103]
    s_waitcnt vmcnt(16)
    v_exp_f32 v78, v78
    v_exp_f32 v79, v79
    v_exp_f32 v80, v80
    v_exp_f32 v81, v81
    v_smfmac_f32_32x32x32_bf16 v[152:167], v[252:255], v[224:231], v32
    s_mov_b64 exec, s[30:31]
    buffer_load_dwordx4 v[248:251], v12, s[12:15], s16 offen offset:0 sc1
    buffer_load_dwordx4 v[252:255], v13, s[12:15], s16 offen offset:1024 sc1
    s_mov_b64 exec, -1
    v_exp_f32 v82, v82
    v_exp_f32 v83, v83
    v_exp_f32 v84, v84
    v_exp_f32 v85, v85
    v_smfmac_f32_32x32x32_bf16 v[104:119], v[24:27], v[72:79], v32
    s_waitcnt vmcnt(15)
    v_exp_f32 v86, v86
    v_exp_f32 v87, v87
    v_exp_f32 v88, v88
    v_exp_f32 v89, v89
    v_mfma_f32_32x32x16_bf16 v[200:215], v[168:171], v[56:59], 0
    s_add_u32 s16, s16, 86016
    v_exp_f32 v90, v90
    v_exp_f32 v91, v91
    v_exp_f32 v92, v92
    v_exp_f32 v93, v93
    v_mfma_f32_32x32x16_bf16 v[200:215], v[172:175], v[60:63], v[200:215]
    s_cmp_eq_u32 s16, s17
    v_exp_f32 v94, v94
    v_exp_f32 v95, v95
    v_exp_f32 v96, v96
    v_exp_f32 v97, v97
    v_smfmac_f32_32x32x32_bf16 v[104:119], v[28:31], v[80:87], v32
    s_cselect_b32 s16, s28, s16
    v_exp_f32 v98, v98
    v_exp_f32 v99, v99
    v_exp_f32 v100, v100
    v_exp_f32 v101, v101
    v_smfmac_f32_32x32x32_bf16 v[120:135], v[24:27], v[88:95], v32
    s_waitcnt vmcnt(12)
    v_exp_f32 v102, v102
    v_exp_f32 v103, v103
    v_exp_f32 v200, v200
    v_exp_f32 v201, v201
    v_mfma_f32_32x32x16_bf16 v[216:231], v[168:171], v[64:67], 0
    v_exp_f32 v202, v202
    v_exp_f32 v203, v203
    v_exp_f32 v204, v204
    v_exp_f32 v205, v205
    v_mfma_f32_32x32x16_bf16 v[216:231], v[172:175], v[68:71], v[216:231]
    buffer_load_dwordx4 v[168:171], v4, s[12:15], s16 offen offset:0 sc1
    v_exp_f32 v206, v206
    v_exp_f32 v207, v207
    v_exp_f32 v208, v208
    v_exp_f32 v209, v209
    v_smfmac_f32_32x32x32_bf16 v[120:135], v[28:31], v[96:103], v32
    buffer_load_dwordx4 v[172:175], v5, s[12:15], s16 offen offset:1024 sc1
    v_exp_f32 v210, v210
    v_exp_f32 v211, v211
    v_exp_f32 v212, v212
    v_exp_f32 v213, v213
    v_smfmac_f32_32x32x32_bf16 v[136:151], v[24:27], v[200:207], v32
    s_waitcnt vmcnt(10)
    v_exp_f32 v214, v214
    v_exp_f32 v215, v215
    v_exp_f32 v216, v216
    v_exp_f32 v217, v217
    v_mfma_f32_32x32x16_bf16 v[72:87], v[176:179], v[40:43], 0
    s_add_u32 s43, s43, 1
    v_exp_f32 v218, v218
    v_exp_f32 v219, v219
    v_exp_f32 v220, v220
    v_exp_f32 v221, v221
    v_mfma_f32_32x32x16_bf16 v[72:87], v[180:183], v[44:47], v[72:87]
    v_exp_f32 v222, v222
    v_exp_f32 v223, v223
    v_exp_f32 v224, v224
    v_exp_f32 v225, v225
    v_smfmac_f32_32x32x32_bf16 v[136:151], v[28:31], v[208:215], v32
    v_exp_f32 v226, v226
    v_exp_f32 v227, v227
    v_exp_f32 v228, v228
    v_exp_f32 v229, v229
    v_smfmac_f32_32x32x32_bf16 v[152:167], v[24:27], v[216:223], v32
    v_exp_f32 v230, v230
    v_exp_f32 v231, v231
    v_exp_f32 v72, v72
    v_exp_f32 v73, v73
    v_mfma_f32_32x32x16_bf16 v[88:103], v[176:179], v[48:51], 0
    v_exp_f32 v74, v74
    v_exp_f32 v75, v75
    v_exp_f32 v76, v76
    v_exp_f32 v77, v77
    v_mfma_f32_32x32x16_bf16 v[88:103], v[180:183], v[52:55], v[88:103]
    v_exp_f32 v78, v78
    v_exp_f32 v79, v79
    v_exp_f32 v80, v80
    v_exp_f32 v81, v81
    v_smfmac_f32_32x32x32_bf16 v[152:167], v[28:31], v[224:231], v32
    s_mov_b64 exec, s[30:31]
    buffer_load_dwordx4 v[24:27], v12, s[12:15], s16 offen offset:0 sc1
    buffer_load_dwordx4 v[28:31], v13, s[12:15], s16 offen offset:1024 sc1
    s_mov_b64 exec, -1
    v_exp_f32 v82, v82
    v_exp_f32 v83, v83
    v_exp_f32 v84, v84
    v_exp_f32 v85, v85
    v_smfmac_f32_32x32x32_bf16 v[104:119], v[232:235], v[72:79], v32
    v_exp_f32 v86, v86
    v_exp_f32 v87, v87
    v_exp_f32 v88, v88
    v_exp_f32 v89, v89
    v_mfma_f32_32x32x16_bf16 v[200:215], v[176:179], v[56:59], 0
    s_add_u32 s16, s16, 86016
    v_exp_f32 v90, v90
    v_exp_f32 v91, v91
    v_exp_f32 v92, v92
    v_exp_f32 v93, v93
    v_mfma_f32_32x32x16_bf16 v[200:215], v[180:183], v[60:63], v[200:215]
    v_exp_f32 v94, v94
    v_exp_f32 v95, v95
    v_exp_f32 v96, v96
    v_exp_f32 v97, v97
    v_smfmac_f32_32x32x32_bf16 v[104:119], v[236:239], v[80:87], v32
    v_exp_f32 v98, v98
    v_exp_f32 v99, v99
    v_exp_f32 v100, v100
    v_exp_f32 v101, v101
    v_smfmac_f32_32x32x32_bf16 v[120:135], v[232:235], v[88:95], v32
    v_exp_f32 v102, v102
    v_exp_f32 v103, v103
    v_exp_f32 v200, v200
    v_exp_f32 v201, v201
    v_mfma_f32_32x32x16_bf16 v[216:231], v[176:179], v[64:67], 0
    v_exp_f32 v202, v202
    v_exp_f32 v203, v203
    v_exp_f32 v204, v204
    v_exp_f32 v205, v205
    v_mfma_f32_32x32x16_bf16 v[216:231], v[180:183], v[68:71], v[216:231]
    buffer_load_dwordx4 v[176:179], v4, s[12:15], s16 offen offset:0 sc1
    v_exp_f32 v206, v206
    v_exp_f32 v207, v207
    v_exp_f32 v208, v208
    v_exp_f32 v209, v209
    v_smfmac_f32_32x32x32_bf16 v[120:135], v[236:239], v[96:103], v32
    buffer_load_dwordx4 v[180:183], v5, s[12:15], s16 offen offset:1024 sc1
    v_exp_f32 v210, v210
    v_exp_f32 v211, v211
    v_exp_f32 v212, v212
    v_exp_f32 v213, v213
    v_smfmac_f32_32x32x32_bf16 v[136:151], v[232:235], v[200:207], v32
    s_waitcnt vmcnt(10)
    v_exp_f32 v214, v214
    v_exp_f32 v215, v215
    v_exp_f32 v216, v216
    v_exp_f32 v217, v217
    v_mfma_f32_32x32x16_bf16 v[72:87], v[184:187], v[40:43], 0
    v_exp_f32 v218, v218
    v_exp_f32 v219, v219
    v_exp_f32 v220, v220
    v_exp_f32 v221, v221
    v_mfma_f32_32x32x16_bf16 v[72:87], v[188:191], v[44:47], v[72:87]
    v_exp_f32 v222, v222
    v_exp_f32 v223, v223
    v_exp_f32 v224, v224
    v_exp_f32 v225, v225
    v_smfmac_f32_32x32x32_bf16 v[136:151], v[236:239], v[208:215], v32
    v_exp_f32 v226, v226
    v_exp_f32 v227, v227
    v_exp_f32 v228, v228
    v_exp_f32 v229, v229
    v_smfmac_f32_32x32x32_bf16 v[152:167], v[232:235], v[216:223], v32
    v_exp_f32 v230, v230
    v_exp_f32 v231, v231
    v_exp_f32 v72, v72
    v_exp_f32 v73, v73
    v_mfma_f32_32x32x16_bf16 v[88:103], v[184:187], v[48:51], 0
    v_exp_f32 v74, v74
    v_exp_f32 v75, v75
    v_exp_f32 v76, v76
    v_exp_f32 v77, v77
    v_mfma_f32_32x32x16_bf16 v[88:103], v[188:191], v[52:55], v[88:103]
    v_exp_f32 v78, v78
    v_exp_f32 v79, v79
    v_exp_f32 v80, v80
    v_exp_f32 v81, v81
    v_smfmac_f32_32x32x32_bf16 v[152:167], v[236:239], v[224:231], v32
    s_mov_b64 exec, s[30:31]
    buffer_load_dwordx4 v[232:235], v12, s[12:15], s16 offen offset:0 sc1
    buffer_load_dwordx4 v[236:239], v13, s[12:15], s16 offen offset:1024 sc1
    s_mov_b64 exec, -1
    v_exp_f32 v82, v82
    v_exp_f32 v83, v83
    v_exp_f32 v84, v84
    v_exp_f32 v85, v85
    v_smfmac_f32_32x32x32_bf16 v[104:119], v[240:243], v[72:79], v32
    v_exp_f32 v86, v86
    v_exp_f32 v87, v87
    v_exp_f32 v88, v88
    v_exp_f32 v89, v89
    v_mfma_f32_32x32x16_bf16 v[200:215], v[184:187], v[56:59], 0
    s_add_u32 s16, s16, 86016
    v_exp_f32 v90, v90
    v_exp_f32 v91, v91
    v_exp_f32 v92, v92
    v_exp_f32 v93, v93
    v_mfma_f32_32x32x16_bf16 v[200:215], v[188:191], v[60:63], v[200:215]
    v_exp_f32 v94, v94
    v_exp_f32 v95, v95
    v_exp_f32 v96, v96
    v_exp_f32 v97, v97
    v_smfmac_f32_32x32x32_bf16 v[104:119], v[244:247], v[80:87], v32
    v_exp_f32 v98, v98
    v_exp_f32 v99, v99
    v_exp_f32 v100, v100
    v_exp_f32 v101, v101
    v_smfmac_f32_32x32x32_bf16 v[120:135], v[240:243], v[88:95], v32
    v_exp_f32 v102, v102
    v_exp_f32 v103, v103
    v_exp_f32 v200, v200
    v_exp_f32 v201, v201
    v_mfma_f32_32x32x16_bf16 v[216:231], v[184:187], v[64:67], 0
    buffer_load_dword v15, v14, s[12:15], 0 offen sc1
    v_exp_f32 v202, v202
    v_exp_f32 v203, v203
    v_exp_f32 v204, v204
    v_exp_f32 v205, v205
    v_mfma_f32_32x32x16_bf16 v[216:231], v[188:191], v[68:71], v[216:231]
    buffer_load_dwordx4 v[184:187], v4, s[12:15], s16 offen offset:0 sc1
    v_exp_f32 v206, v206
    v_exp_f32 v207, v207
    v_exp_f32 v208, v208
    v_exp_f32 v209, v209
    v_smfmac_f32_32x32x32_bf16 v[120:135], v[244:247], v[96:103], v32
    buffer_load_dwordx4 v[188:191], v5, s[12:15], s16 offen offset:1024 sc1
    v_exp_f32 v210, v210
    v_exp_f32 v211, v211
    v_exp_f32 v212, v212
    v_exp_f32 v213, v213
    v_smfmac_f32_32x32x32_bf16 v[136:151], v[240:243], v[200:207], v32
    s_waitcnt vmcnt(10)
    v_exp_f32 v214, v214
    v_exp_f32 v215, v215
    v_exp_f32 v216, v216
    v_exp_f32 v217, v217
    v_mfma_f32_32x32x16_bf16 v[72:87], v[192:195], v[40:43], 0
    v_exp_f32 v218, v218
    v_exp_f32 v219, v219
    v_exp_f32 v220, v220
    v_exp_f32 v221, v221
    v_mfma_f32_32x32x16_bf16 v[72:87], v[196:199], v[44:47], v[72:87]
    v_exp_f32 v222, v222
    v_exp_f32 v223, v223
    v_exp_f32 v224, v224
    v_exp_f32 v225, v225
    v_smfmac_f32_32x32x32_bf16 v[136:151], v[244:247], v[208:215], v32
    v_exp_f32 v226, v226
    v_exp_f32 v227, v227
    v_exp_f32 v228, v228
    v_exp_f32 v229, v229
    v_smfmac_f32_32x32x32_bf16 v[152:167], v[240:243], v[216:223], v32
    v_exp_f32 v230, v230
    v_exp_f32 v231, v231
    v_exp_f32 v72, v72
    v_exp_f32 v73, v73
    v_mfma_f32_32x32x16_bf16 v[88:103], v[192:195], v[48:51], 0
    v_exp_f32 v74, v74
    v_exp_f32 v75, v75
    v_exp_f32 v76, v76
    v_exp_f32 v77, v77
    v_mfma_f32_32x32x16_bf16 v[88:103], v[196:199], v[52:55], v[88:103]
    v_exp_f32 v78, v78
    v_exp_f32 v79, v79
    v_exp_f32 v80, v80
    v_exp_f32 v81, v81
    v_smfmac_f32_32x32x32_bf16 v[152:167], v[244:247], v[224:231], v32
    s_mov_b64 exec, s[30:31]
    buffer_load_dwordx4 v[240:243], v12, s[12:15], s16 offen offset:0 sc1
    buffer_load_dwordx4 v[244:247], v13, s[12:15], s16 offen offset:1024 sc1
    s_mov_b64 exec, -1
    v_exp_f32 v82, v82
    v_exp_f32 v83, v83
    v_exp_f32 v84, v84
    v_exp_f32 v85, v85
    v_smfmac_f32_32x32x32_bf16 v[104:119], v[248:251], v[72:79], v32
    v_exp_f32 v86, v86
    v_exp_f32 v87, v87
    v_exp_f32 v88, v88
    v_exp_f32 v89, v89
    v_mfma_f32_32x32x16_bf16 v[200:215], v[192:195], v[56:59], 0
    s_add_u32 s16, s16, 86016
    v_exp_f32 v90, v90
    v_exp_f32 v91, v91
    v_exp_f32 v92, v92
    v_exp_f32 v93, v93
    v_mfma_f32_32x32x16_bf16 v[200:215], v[196:199], v[60:63], v[200:215]
    v_exp_f32 v94, v94
    v_exp_f32 v95, v95
    v_exp_f32 v96, v96
    v_exp_f32 v97, v97
    v_smfmac_f32_32x32x32_bf16 v[104:119], v[252:255], v[80:87], v32
    v_exp_f32 v98, v98
    v_exp_f32 v99, v99
    v_exp_f32 v100, v100
    v_exp_f32 v101, v101
    v_smfmac_f32_32x32x32_bf16 v[120:135], v[248:251], v[88:95], v32
    v_exp_f32 v102, v102
    v_exp_f32 v103, v103
    v_exp_f32 v200, v200
    v_exp_f32 v201, v201
    v_mfma_f32_32x32x16_bf16 v[216:231], v[192:195], v[64:67], 0
    v_exp_f32 v202, v202
    v_exp_f32 v203, v203
    v_exp_f32 v204, v204
    v_exp_f32 v205, v205
    v_mfma_f32_32x32x16_bf16 v[216:231], v[196:199], v[68:71], v[216:231]
    buffer_load_dwordx4 v[192:195], v4, s[12:15], s16 offen offset:0 sc1
    v_exp_f32 v206, v206
    v_exp_f32 v207, v207
    v_exp_f32 v208, v208
    v_exp_f32 v209, v209
    v_smfmac_f32_32x32x32_bf16 v[120:135], v[252:255], v[96:103], v32
    buffer_load_dwordx4 v[196:199], v5, s[12:15], s16 offen offset:1024 sc1
    v_exp_f32 v210, v210
    v_exp_f32 v211, v211
    v_exp_f32 v212, v212
    v_exp_f32 v213, v213
    v_smfmac_f32_32x32x32_bf16 v[136:151], v[248:251], v[200:207], v32
    s_waitcnt vmcnt(10)
    v_exp_f32 v214, v214
    v_exp_f32 v215, v215
    v_exp_f32 v216, v216
    v_exp_f32 v217, v217
    v_mfma_f32_32x32x16_bf16 v[72:87], v[168:171], v[40:43], 0
    v_exp_f32 v218, v218
    v_exp_f32 v219, v219
    v_exp_f32 v220, v220
    v_exp_f32 v221, v221
    v_mfma_f32_32x32x16_bf16 v[72:87], v[172:175], v[44:47], v[72:87]
    v_exp_f32 v222, v222
    v_exp_f32 v223, v223
    v_exp_f32 v224, v224
    v_exp_f32 v225, v225
    v_smfmac_f32_32x32x32_bf16 v[136:151], v[252:255], v[208:215], v32
    v_exp_f32 v226, v226
    v_exp_f32 v227, v227
    v_exp_f32 v228, v228
    v_exp_f32 v229, v229
    v_smfmac_f32_32x32x32_bf16 v[152:167], v[248:251], v[216:223], v32
    s_cmp_lt_u32 s43, 3
    v_exp_f32 v230, v230
    v_exp_f32 v231, v231
    s_cbranch_scc1 A_loop
L_last:
    v_exp_f32 v72, v72
    v_exp_f32 v73, v73
    v_mfma_f32_32x32x16_bf16 v[88:103], v[168:171], v[48:51], 0
    v_exp_f32 v74, v74
    v_exp_f32 v75, v75
    v_exp_f32 v76, v76
    v_exp_f32 v77, v77
    v_mfma_f32_32x32x16_bf16 v[88:103], v[172:175], v[52:55], v[88:103]
    v_exp_f32 v78, v78
    v_exp_f32 v79, v79
    v_exp_f32 v80, v80
    v_exp_f32 v81, v81
    v_smfmac_f32_32x32x32_bf16 v[152:167], v[252:255], v[224:231], v32
    s_mov_b64 exec, s[30:31]
    buffer_load_dwordx4 v[248:251], v12, s[12:15], s16 offen offset:0 sc1
    buffer_load_dwordx4 v[252:255], v13, s[12:15], s16 offen offset:1024 sc1
    s_mov_b64 exec, -1
    v_exp_f32 v82, v82
    v_exp_f32 v83, v83
    v_exp_f32 v84, v84
    v_exp_f32 v85, v85
    v_smfmac_f32_32x32x32_bf16 v[104:119], v[24:27], v[72:79], v32
    buffer_load_dword v15, v14, s[12:15], 0 offen sc1
    v_exp_f32 v86, v86
    v_exp_f32 v87, v87
    v_exp_f32 v88, v88
    v_exp_f32 v89, v89
    v_mfma_f32_32x32x16_bf16 v[200:215], v[168:171], v[56:59], 0
    v_exp_f32 v90, v90
    v_exp_f32 v91, v91
    v_exp_f32 v92, v92
    v_exp_f32 v93, v93
    v_mfma_f32_32x32x16_bf16 v[200:215], v[172:175], v[60:63], v[200:215]
    v_exp_f32 v94, v94
    v_exp_f32 v95, v95
    v_exp_f32 v96, v96
    v_exp_f32 v97, v97
    v_smfmac_f32_32x32x32_bf16 v[104:119], v[28:31], v[80:87], v32
    v_exp_f32 v98, v98
    v_exp_f32 v99, v99
    v_exp_f32 v100, v100
    v_exp_f32 v101, v101
    v_smfmac_f32_32x32x32_bf16 v[120:135], v[24:27], v[88:95], v32
    s_waitcnt vmcnt(9)
    v_exp_f32 v102, v102
    v_exp_f32 v103, v103
    v_exp_f32 v200, v200
    v_exp_f32 v201, v201
    v_mfma_f32_32x32x16_bf16 v[216:231], v[176:179], v[40:43], 0
    v_exp_f32 v202, v202
    v_exp_f32 v203, v203
    v_exp_f32 v204, v204
    v_exp_f32 v205, v205
    v_mfma_f32_32x32x16_bf16 v[216:231], v[180:183], v[44:47], v[216:231]
    v_exp_f32 v206, v206
    v_exp_f32 v207, v207
    v_exp_f32 v208, v208
    v_exp_f32 v209, v209
    v_smfmac_f32_32x32x32_bf16 v[120:135], v[28:31], v[96:103], v32
    v_exp_f32 v210, v210
    v_exp_f32 v211, v211
    v_exp_f32 v212, v212
    v_exp_f32 v213, v213
    v_smfmac_f32_32x32x32_bf16 v[136:151], v[24:27], v[200:207], v32
    v_exp_f32 v214, v214
    v_exp_f32 v215, v215
    v_exp_f32 v216, v216
    v_exp_f32 v217, v217
    v_mfma_f32_32x32x16_bf16 v[72:87], v[176:179], v[48:51], 0
    v_exp_f32 v218, v218
    v_exp_f32 v219, v219
    v_exp_f32 v220, v220
    v_exp_f32 v221, v221
    v_mfma_f32_32x32x16_bf16 v[72:87], v[180:183], v[52:55], v[72:87]
    v_exp_f32 v222, v222
    v_exp_f32 v223, v223
    v_exp_f32 v224, v224
    v_exp_f32 v225, v225
    v_smfmac_f32_32x32x32_bf16 v[136:151], v[28:31], v[208:215], v32
    v_exp_f32 v226, v226
    v_exp_f32 v227, v227
    v_exp_f32 v228, v228
    v_exp_f32 v229, v229
    v_smfmac_f32_32x32x32_bf16 v[104:119], v[232:235], v[216:223], v32
    v_exp_f32 v230, v230
    v_exp_f32 v231, v231
    v_exp_f32 v72, v72
    v_exp_f32 v73, v73
    v_mfma_f32_32x32x16_bf16 v[88:103], v[176:179], v[56:59], 0
    v_exp_f32 v74, v74
    v_exp_f32 v75, v75
    v_exp_f32 v76, v76
    v_exp_f32 v77, v77
    v_mfma_f32_32x32x16_bf16 v[88:103], v[180:183], v[60:63], v[88:103]
    v_exp_f32 v78, v78
    v_exp_f32 v79, v79
    v_exp_f32 v80, v80
    v_exp_f32 v81, v81
    v_smfmac_f32_32x32x32_bf16 v[104:119], v[236:239], v[224:231], v32
    v_exp_f32 v82, v82
    v_exp_f32 v83, v83
    v_exp_f32 v84, v84
    v_exp_f32 v85, v85
    v_smfmac_f32_32x32x32_bf16 v[120:135], v[232:235], v[72:79], v32
    s_waitcnt vmcnt(5)
    v_exp_f32 v86, v86
    v_exp_f32 v87, v87
    v_exp_f32 v88, v88
    v_exp_f32 v89, v89
    v_mfma_f32_32x32x16_bf16 v[200:215], v[184:187], v[40:43], 0
    v_exp_f32 v90, v90
    v_exp_f32 v91, v91
    v_exp_f32 v92, v92
    v_exp_f32 v93, v93
    v_mfma_f32_32x32x16_bf16 v[200:215], v[188:191], v[44:47], v[200:215]
    v_exp_f32 v94, v94
    v_exp_f32 v95, v95
    v_exp_f32 v96, v96
    v_exp_f32 v97, v97
    v_smfmac_f32_32x32x32_bf16 v[120:135], v[236:239], v[80:87], v32
    v_exp_f32 v98, v98
    v_exp_f32 v99, v99
    v_exp_f32 v100, v100
    v_exp_f32 v101, v101
    v_smfmac_f32_32x32x32_bf16 v[136:151], v[232:235], v[88:95], v32
    v_exp_f32 v102, v102
    v_exp_f32 v103, v103
    v_exp_f32 v200, v200
    v_exp_f32 v201, v201
    v_mfma_f32_32x32x16_bf16 v[216:231], v[184:187], v[48:51], 0
    v_exp_f32 v202, v202
    v_exp_f32 v203, v203
    v_exp_f32 v204, v204
    v_exp_f32 v205, v205
    v_mfma_f32_32x32x16_bf16 v[216:231], v[188:191], v[52:55], v[216:231]
    v_exp_f32 v206, v206
    v_exp_f32 v207, v207
    v_exp_f32 v208, v208
    v_exp_f32 v209, v209
    v_smfmac_f32_32x32x32_bf16 v[136:151], v[236:239], v[96:103], v32
    v_exp_f32 v210, v210
    v_exp_f32 v211, v211
    v_exp_f32 v212, v212
    v_exp_f32 v213, v213
    v_smfmac_f32_32x32x32_bf16 v[104:119], v[240:243], v[200:207], v32
    v_exp_f32 v214, v214
    v_exp_f32 v215, v215
    v_exp_f32 v216, v216
    v_exp_f32 v217, v217
    v_mfma_f32_32x32x16_bf16 v[72:87], v[184:187], v[56:59], 0
    v_exp_f32 v218, v218
    v_exp_f32 v219, v219
    v_exp_f32 v220, v220
    v_exp_f32 v221, v221
    v_mfma_f32_32x32x16_bf16 v[72:87], v[188:191], v[60:63], v[72:87]
    v_exp_f32 v222, v222
    v_exp_f32 v223, v223
    v_exp_f32 v224, v224
    v_exp_f32 v225, v225
    v_smfmac_f32_32x32x32_bf16 v[104:119], v[244:247], v[208:215], v32
    v_exp_f32 v226, v226
    v_exp_f32 v227, v227
    v_exp_f32 v228, v228
    v_exp_f32 v229, v229
    v_smfmac_f32_32x32x32_bf16 v[120:135], v[240:243], v[216:223], v32
    s_waitcnt vmcnt(3)
    v_exp_f32 v230, v230
    v_exp_f32 v231, v231
    v_exp_f32 v72, v72
    v_exp_f32 v73, v73
    v_mfma_f32_32x32x16_bf16 v[88:103], v[192:195], v[40:43], 0
    v_exp_f32 v74, v74
    v_exp_f32 v75, v75
    v_exp_f32 v76, v76
    v_exp_f32 v77, v77
    v_mfma_f32_32x32x16_bf16 v[88:103], v[196:199], v[44:47], v[88:103]
    v_exp_f32 v78, v78
    v_exp_f32 v79, v79
    v_exp_f32 v80, v80
    v_exp_f32 v81, v81
    v_smfmac_f32_32x32x32_bf16 v[120:135], v[244:247], v[224:231], v32
    ds_read_b32 v19, v10 offset:61444
    v_exp_f32 v82, v82
    v_exp_f32 v83, v83
    v_exp_f32 v84, v84
    v_exp_f32 v85, v85
    v_smfmac_f32_32x32x32_bf16 v[136:151], v[240:243], v[72:79], v32
    v_exp_f32 v86, v86
    v_exp_f32 v87, v87
    v_exp_f32 v88, v88
    v_exp_f32 v89, v89
    v_mfma_f32_32x32x16_bf16 v[200:215], v[192:195], v[48:51], 0
    v_exp_f32 v90, v90
    v_exp_f32 v91, v91
    v_exp_f32 v92, v92
    v_exp_f32 v93, v93
    v_mfma_f32_32x32x16_bf16 v[200:215], v[196:199], v[52:55], v[200:215]
    s_waitcnt vmcnt(1) lgkmcnt(0)
    v_exp_f32 v94, v94
    v_exp_f32 v95, v95
    v_exp_f32 v96, v96
    v_exp_f32 v97, v97
    v_smfmac_f32_32x32x32_bf16 v[136:151], v[244:247], v[80:87], v32
    s_mul_i32 s41, s3, 12288
    v_cmp_ne_u32 vcc, 4, v19
    v_exp_f32 v98, v98
    v_exp_f32 v99, v99
    v_exp_f32 v100, v100
    v_exp_f32 v101, v101
    v_smfmac_f32_32x32x32_bf16 v[104:119], v[248:251], v[88:95], v32
    s_cbranch_vccnz A_ysp
A_yok:
    v_exp_f32 v102, v102
    v_exp_f32 v103, v103
    v_exp_f32 v200, v200
    v_exp_f32 v201, v201
    v_mfma_f32_32x32x16_bf16 v[216:231], v[192:195], v[56:59], 0
    v_add_u32 v16, s41, v1
    v_exp_f32 v202, v202
    v_exp_f32 v203, v203
    v_exp_f32 v204, v204
    v_exp_f32 v205, v205
    v_mfma_f32_32x32x16_bf16 v[216:231], v[196:199], v[60:63], v[216:231]
    v_exp_f32 v206, v206
    v_exp_f32 v207, v207
    v_exp_f32 v208, v208
    v_exp_f32 v209, v209
    v_smfmac_f32_32x32x32_bf16 v[104:119], v[252:255], v[96:103], v32
    v_exp_f32 v210, v210
    v_exp_f32 v211, v211
    v_exp_f32 v212, v212
    v_exp_f32 v213, v213
    v_smfmac_f32_32x32x32_bf16 v[120:135], v[248:251], v[200:207], v32
    v_exp_f32 v214, v214
    v_exp_f32 v215, v215
    v_exp_f32 v216, v216
    v_exp_f32 v217, v217
    v_mfma_f32_32x32x16_bf16 v[72:87], v[168:171], v[64:67], 0
    v_exp_f32 v218, v218
    v_exp_f32 v219, v219
    v_exp_f32 v220, v220
    v_exp_f32 v221, v221
    v_mfma_f32_32x32x16_bf16 v[72:87], v[172:175], v[68:71], v[72:87]
    ds_write_b128 v20, v[104:107] offset:0
    v_exp_f32 v222, v222
    v_exp_f32 v223, v223
    v_exp_f32 v224, v224
    v_exp_f32 v225, v225
    v_smfmac_f32_32x32x32_bf16 v[120:135], v[252:255], v[208:215], v32
    ds_write_b128 v20, v[108:111] offset:1024
    v_exp_f32 v226, v226
    v_exp_f32 v227, v227
    v_exp_f32 v228, v228
    v_exp_f32 v229, v229
    v_smfmac_f32_32x32x32_bf16 v[136:151], v[248:251], v[216:223], v32
    ds_write_b128 v20, v[112:115] offset:2048
    v_exp_f32 v230, v230
    v_exp_f32 v231, v231
    v_exp_f32 v72, v72
    v_exp_f32 v73, v73
    v_mfma_f32_32x32x16_bf16 v[88:103], v[176:179], v[64:67], 0
    ds_write_b128 v20, v[116:119] offset:3072
    v_exp_f32 v74, v74
    v_exp_f32 v75, v75
    v_exp_f32 v76, v76
    v_exp_f32 v77, v77
    v_mfma_f32_32x32x16_bf16 v[88:103], v[180:183], v[68:71], v[88:103]
    ds_write_b128 v21, v[120:123] offset:4096
    v_exp_f32 v78, v78
    v_exp_f32 v79, v79
    v_exp_f32 v80, v80
    v_exp_f32 v81, v81
    v_smfmac_f32_32x32x32_bf16 v[136:151], v[252:255], v[224:231], v32
    ds_write_b128 v21, v[124:127] offset:5120
    v_exp_f32 v82, v82
    v_exp_f32 v83, v83
    v_exp_f32 v84, v84
    v_exp_f32 v85, v85
    v_smfmac_f32_32x32x32_bf16 v[152:167], v[24:27], v[72:79], v32
    ds_write_b128 v21, v[128:131] offset:6144
    v_exp_f32 v86, v86
    v_exp_f32 v87, v87
    v_exp_f32 v88, v88
    v_exp_f32 v89, v89
    v_mfma_f32_32x32x16_bf16 v[200:215], v[184:187], v[64:67], 0
    ds_write_b128 v21, v[132:135] offset:7168
    v_exp_f32 v90, v90
    v_exp_f32 v91, v91
    v_exp_f32 v92, v92
    v_exp_f32 v93, v93
    v_mfma_f32_32x32x16_bf16 v[200:215], v[188:191], v[68:71], v[200:215]
    ds_write_b128 v22, v[136:139] offset:8192
    v_exp_f32 v94, v94
    v_exp_f32 v95, v95
    v_exp_f32 v96, v96
    v_exp_f32 v97, v97
    v_smfmac_f32_32x32x32_bf16 v[152:167], v[28:31], v[80:87], v32
    ds_write_b128 v22, v[140:143] offset:9216
    v_exp_f32 v98, v98
    v_exp_f32 v99, v99
    v_exp_f32 v100, v100
    v_exp_f32 v101, v101
    v_smfmac_f32_32x32x32_bf16 v[152:167], v[232:235], v[88:95], v32
    ds_write_b128 v22, v[144:147] offset:10240
    v_exp_f32 v102, v102
    v_exp_f32 v103, v103
    v_exp_f32 v200, v200
    v_exp_f32 v201, v201
    v_mfma_f32_32x32x16_bf16 v[216:231], v[192:195], v[64:67], 0
    ds_write_b128 v22, v[148:151] offset:11264
    v_exp_f32 v202, v202
    v_exp_f32 v203, v203
    v_exp_f32 v204, v204
    v_exp_f32 v205, v205
    v_mfma_f32_32x32x16_bf16 v[216:231], v[196:199], v[68:71], v[216:231]
    v_exp_f32 v206, v206
    v_exp_f32 v207, v207
    v_exp_f32 v208, v208
    v_exp_f32 v209, v209
    v_smfmac_f32_32x32x32_bf16 v[152:167], v[236:239], v[96:103], v32
    v_exp_f32 v210, v210
    v_exp_f32 v211, v211
    v_exp_f32 v212, v212
    v_exp_f32 v213, v213
    v_smfmac_f32_32x32x32_bf16 v[152:167], v[240:243], v[200:207], v32
    s_waitcnt lgkmcnt(0)
    v_exp_f32 v214, v214
    v_exp_f32 v215, v215
    v_exp_f32 v216, v216
    v_exp_f32 v217, v217
    v_smfmac_f32_32x32x32_bf16 v[152:167], v[244:247], v[208:215], v32
    s_barrier
    ds_read_b128 v[104:107], v16 offset:0
    ds_read_b128 v[108:111], v16 offset:1024
    ds_read_b128 v[112:115], v16 offset:2048
    ds_read_b128 v[116:119], v16 offset:3072
    ds_read_b128 v[120:123], v16 offset:4096
    ds_read_b128 v[124:127], v16 offset:5120
    v_exp_f32 v218, v218
    v_exp_f32 v219, v219
    v_exp_f32 v220, v220
    v_exp_f32 v221, v221
    v_exp_f32 v222, v222
    v_exp_f32 v223, v223
    v_exp_f32 v224, v224
    v_exp_f32_e64 v225, v225
    v_smfmac_f32_32x32x32_bf16 v[152:167], v[248:251], v[216:223], v32
    ds_read_b128 v[128:131], v16 offset:6144
    ds_read_b128 v[132:135], v16 offset:7168
    ds_read_b128 v[136:139], v16 offset:8192
    ds_read_b128 v[140:143], v16 offset:9216
    ds_read_b128 v[144:147], v16 offset:10240
    ds_read_b128 v[148:151], v16 offset:11264
    v_exp_f32 v226, v226
    v_exp_f32 v227, v227
    v_exp_f32 v228, v228
    v_exp_f32 v229, v229
    v_exp_f32 v230, v230
    v_exp_f32 v231, v231
L_tail:
    s_waitcnt lgkmcnt(4)
    s_mov_b32 s44, 0
    v_smfmac_f32_32x32x32_bf16 v[152:167], v[252:255], v[224:231], v32
    v_add_f32 v104, v104, v120
    v_add_f32 v105, v105, v121
    v_add_f32 v106, v106, v122
    v_add_f32 v107, v107, v123
    v_add_f32 v108, v108, v124
    v_add_f32 v109, v109, v125
    v_add_f32 v110, v110, v126
    v_add_f32 v111, v111, v127
    v_add_f32 v112, v112, v128
    v_add_f32 v113, v113, v129
    v_add_f32 v114, v114, v130
    v_add_f32 v115, v115, v131
    v_add_f32 v116, v116, v132
    v_add_f32 v117, v117, v133
    v_add_f32 v118, v118, v134
    v_add_f32 v119, v119, v135
    s_waitcnt lgkmcnt(0)
    v_pk_add_f32 v[116:117], v[116:117], v[148:149]
    v_pk_add_f32 v[164:165], v[164:165], v[116:117]
    v_mov_b32 v18, v164
    v_mov_b32 v19, v164
    s_mov_b32 s46, 0x30800000
    s_mov_b32 s47, 0x4e800000
    v_permlane32_swap_b32 v18, v19
    s_mov_b32 exec_lo, 0
    v_mov_b32 v164, 0
    s_mov_b32 exec_lo, -1
    v_rcp_f32 v18, v19
    v_cmp_nge_f32 vcc, v19, s46
    v_cmp_nle_f32 s[66:67], v19, s47
    s_or_b64 vcc, vcc, s[66:67]
    s_cbranch_vccnz L_slow
    v_pk_add_f32 v[104:105], v[104:105], v[136:137]
    v_pk_add_f32 v[106:107], v[106:107], v[138:139]
    v_pk_add_f32 v[108:109], v[108:109], v[140:141]
    v_pk_add_f32 v[110:111], v[110:111], v[142:143]
    v_pk_add_f32 v[112:113], v[112:113], v[144:145]
    v_pk_add_f32 v[114:115], v[114:115], v[146:147]
    v_pk_add_f32 v[118:119], v[118:119], v[150:151]
    v_pk_add_f32 v[152:153], v[152:153], v[104:105]
    v_pk_add_f32 v[154:155], v[154:155], v[106:107]
    v_pk_add_f32 v[156:157], v[156:157], v[108:109]
    v_pk_add_f32 v[158:159], v[158:159], v[110:111]
    v_pk_add_f32 v[160:161], v[160:161], v[112:113]
    v_pk_add_f32 v[162:163], v[162:163], v[114:115]
    v_pk_add_f32 v[166:167], v[166:167], v[118:119]
A_store:
    v_pk_mul_f32 v[152:153], v[152:153], v[18:19] op_sel_hi:[1,0]
    v_pk_mul_f32 v[154:155], v[154:155], v[18:19] op_sel_hi:[1,0]
    v_pk_mul_f32 v[156:157], v[156:157], v[18:19] op_sel_hi:[1,0]
    v_pk_mul_f32 v[158:159], v[158:159], v[18:19] op_sel_hi:[1,0]
    v_cvt_pk_bf16_f32 v104, v152, v153
    v_cvt_pk_bf16_f32 v105, v154, v155
    v_cvt_pk_bf16_f32 v106, v156, v157
    v_cvt_pk_bf16_f32 v107, v158, v159
    v_pk_mul_f32 v[160:161], v[160:161], v[18:19] op_sel_hi:[1,0]
    v_pk_mul_f32 v[162:163], v[162:163], v[18:19] op_sel_hi:[1,0]
    v_pk_mul_f32 v[164:165], v[164:165], v[18:19] op_sel_hi:[1,0]
    v_pk_mul_f32 v[166:167], v[166:167], v[18:19] op_sel_hi:[1,0]
    v_cvt_pk_bf16_f32 v108, v160, v161
    v_cvt_pk_bf16_f32 v109, v162, v163
    v_cvt_pk_bf16_f32 v110, v164, v165
    v_cvt_pk_bf16_f32 v111, v166, v167
    v_permlane32_swap_b32 v104, v106
    v_permlane32_swap_b32 v105, v107
    v_permlane32_swap_b32 v108, v110
    v_permlane32_swap_b32 v109, v111
    buffer_store_dwordx4 v[104:107], v1, s[12:15], s42 offen offset:0
    buffer_store_dwordx4 v[108:111], v1, s[12:15], s42 offen offset:1024
    s_barrier
    s_and_b32 s44, s3, 1
    s_lshr_b32 s45, s3, 1
    s_bfe_u32 s34, s69, 0x30002
    s_and_b32 s46, s69, 3
    s_lshl2_add_u32 s46, s68, s46
    s_lshl1_add_u32 s46, s46, s44
    s_lshl1_add_u32 s47, s34, s45
    v_bfe_u32 v16, v0, 2, 2
    v_lshl_add_u32 v16, v3, 2, v16
    v_lshlrev_b32 v16, 6, v16
    v_and_b32 v17, 16, v0
    v_lshl_add_u32 v16, v17, 1, v16
    v_and_b32 v22, 3, v0
    v_lshl_add_u32 v16, v22, 3, v16
    s_mul_i32 s41, s3, 2304
    s_add_u32 s41, s41, 49152
    v_add_u32 v5, s41, v16
    s_lshl_b32 s43, s44, 7
    s_add_u32 s41, s41, s43
    v_lshl_add_u32 v6, v2, 2, s41
    v_lshl_add_u32 v16, v3, 8, v16
    s_mul_i32 s41, s45, 28672
    s_add_u32 s41, s41, 65536
    v_add_u32 v4, s41, v16
    v_lshlrev_b32 v16, 9, v0
    s_lshr_b32 s41, s46, 2
    s_lshl1_add_u32 s41, s41, s45
    s_lshl_b32 s41, s41, 5
    s_and_b32 s43, s46, 3
    s_add_u32 s41, s41, s43
    s_lshl_b32 s41, s41, 7
    s_add_u32 s41, s41, 14155776
    s_lshl1_add_u32 s42, s46, s45
    s_lshl_b32 s42, s42, 14
    s_add_u32 s42, s42, 11534336
    s_cmp_eq_u32 s44, 0
    s_cselect_b32 s43, 123136, 0
    v_add_u32 v7, s43, v1
    s_lshl_b32 s23, s45, 14
    s_add_u32 m0, s43, s23
    s_nop 0
    ds_read_b32 v6, v6 offset:2048
    ds_read_b64_tr_b16 v[24:25], v5 offset:0
    ds_read_b64_tr_b16 v[26:27], v5 offset:512
    ds_read_b64_tr_b16 v[28:29], v5 offset:1024
    ds_read_b64_tr_b16 v[30:31], v5 offset:1536
    ds_read_b64_tr_b16 v[128:129], v4 offset:0
    ds_read_b64_tr_b16 v[130:131], v4 offset:256
    ds_read_b64_tr_b16 v[132:133], v4 offset:1024
    ds_read_b64_tr_b16 v[134:135], v4 offset:1280
    ds_read_b64_tr_b16 v[136:137], v4 offset:14336
    ds_read_b64_tr_b16 v[138:139], v4 offset:14592
    ds_read_b64_tr_b16 v[140:141], v4 offset:15360
    ds_read_b64_tr_b16 v[142:143], v4 offset:15616
    ds_read_b64_tr_b16 v[144:145], v4 offset:1792
    ds_read_b64_tr_b16 v[146:147], v4 offset:2048
    s_waitcnt vmcnt(0)
    s_mov_b64 exec, 1
    buffer_store_dwordx2 v[8:9], v10, s[12:15], s21 offen
    s_mov_b64 exec, -1
    s_cmp_eq_u32 s34, 7
    s_cbranch_scc1 L_end
    s_nop 0
    ds_read_b64_tr_b16 v[148:149], v4 offset:2816
    ds_read_b64_tr_b16 v[150:151], v4 offset:3072
    ds_read_b64_tr_b16 v[152:153], v4 offset:16128
    ds_read_b64_tr_b16 v[154:155], v4 offset:16384
    ds_read_b64_tr_b16 v[156:157], v4 offset:17152
    ds_read_b64_tr_b16 v[158:159], v4 offset:17408
    ds_read_b64_tr_b16 v[160:161], v4 offset:3584
    ds_read_b64_tr_b16 v[162:163], v4 offset:3840
    ds_read_b64_tr_b16 v[164:165], v4 offset:4608
    ds_read_b64_tr_b16 v[166:167], v4 offset:4864
    ds_read_b64_tr_b16 v[168:169], v4 offset:5376
    ds_read_b64_tr_b16 v[170:171], v4 offset:5632
    ds_read_b64_tr_b16 v[172:173], v4 offset:6400
    ds_read_b64_tr_b16 v[174:175], v4 offset:6656
    ds_read_b64_tr_b16 v[176:177], v4 offset:17920
    ds_read_b64_tr_b16 v[178:179], v4 offset:18176
    ds_read_b64_tr_b16 v[180:181], v4 offset:18944
    ds_read_b64_tr_b16 v[182:183], v4 offset:19200
    ds_read_b64_tr_b16 v[184:185], v4 offset:19712
    ds_read_b64_tr_b16 v[186:187], v4 offset:19968
    ds_read_b64_tr_b16 v[188:189], v4 offset:20736
    ds_read_b64_tr_b16 v[190:191], v4 offset:20992
    s_mov_b32 s60, 0
    s_mov_b32 exec_lo, 0xff
    s_mov_b32 exec_hi, 0x0
O_spo:
    buffer_load_dwordx2 v[18:19], v16, s[12:15], s41 offen sc1
    s_add_u32 s60, s60, 1
    s_cmp_gt_u32 s60, 400000
    s_cbranch_scc1 L_end
    s_waitcnt vmcnt(0)
    v_cmp_ne_u64 vcc, v[18:19], s[62:63]
    s_and_b64 exec, exec, vcc
    s_cbranch_scc1 O_spo
    s_mov_b64 exec, -1
    buffer_load_dwordx4 v1, s[12:15], s42 offen offset:0 sc1 lds
    buffer_load_dwordx4 v1, s[12:15], s42 offen offset:1024 sc1 lds
    buffer_load_dwordx4 v1, s[12:15], s42 offen offset:2048 sc1 lds
    buffer_load_dwordx4 v1, s[12:15], s42 offen offset:3072 sc1 lds
    s_add_u32 m0, m0, 4096
    s_add_u32 s42, s42, 4096
    buffer_load_dwordx4 v1, s[12:15], s42 offen offset:0 sc1 lds
    buffer_load_dwordx4 v1, s[12:15], s42 offen offset:1024 sc1 lds
    buffer_load_dwordx4 v1, s[12:15], s42 offen offset:2048 sc1 lds
    buffer_load_dwordx4 v1, s[12:15], s42 offen offset:3072 sc1 lds
    ds_read_b64_tr_b16 v[192:193], v4 offset:7168
    ds_read_b64_tr_b16 v[194:195], v4 offset:7424
    ds_read_b64_tr_b16 v[196:197], v4 offset:8192
    ds_read_b64_tr_b16 v[198:199], v4 offset:8448
    ds_read_b64_tr_b16 v[200:201], v4 offset:8960
    ds_read_b64_tr_b16 v[202:203], v4 offset:9216
    ds_read_b64_tr_b16 v[204:205], v4 offset:9984
    ds_read_b64_tr_b16 v[206:207], v4 offset:10240
    ds_read_b64_tr_b16 v[208:209], v4 offset:21504
    ds_read_b64_tr_b16 v[210:211], v4 offset:21760
    ds_read_b64_tr_b16 v[212:213], v4 offset:22528
    ds_read_b64_tr_b16 v[214:215], v4 offset:22784
    ds_read_b64_tr_b16 v[216:217], v4 offset:23296
    ds_read_b64_tr_b16 v[218:219], v4 offset:23552
    ds_read_b64_tr_b16 v[220:221], v4 offset:24320
    ds_read_b64_tr_b16 v[222:223], v4 offset:24576
    ds_read_b64_tr_b16 v[224:225], v4 offset:10752
    ds_read_b64_tr_b16 v[226:227], v4 offset:11008
    ds_read_b64_tr_b16 v[228:229], v4 offset:11776
    ds_read_b64_tr_b16 v[230:231], v4 offset:12032
    ds_read_b64_tr_b16 v[232:233], v4 offset:12544
    ds_read_b64_tr_b16 v[234:235], v4 offset:12800
    ds_read_b64_tr_b16 v[236:237], v4 offset:13568
    ds_read_b64_tr_b16 v[238:239], v4 offset:13824
    ds_read_b64_tr_b16 v[240:241], v4 offset:25088
    ds_read_b64_tr_b16 v[242:243], v4 offset:25344
    ds_read_b64_tr_b16 v[244:245], v4 offset:26112
    ds_read_b64_tr_b16 v[246:247], v4 offset:26368
    ds_read_b64_tr_b16 v[248:249], v4 offset:26880
    ds_read_b64_tr_b16 v[250:251], v4 offset:27136
    ds_read_b64_tr_b16 v[252:253], v4 offset:27904
    ds_read_b64_tr_b16 v[254:255], v4 offset:28160
    s_waitcnt vmcnt(6) lgkmcnt(0)
    s_barrier
    ds_read_b128 v[64:67], v7 offset:0
    ds_read_b128 v[68:71], v7 offset:1024
    ds_read_b128 v[72:75], v7 offset:16384
    s_waitcnt lgkmcnt(2)
    v_mfma_f32_32x32x16_bf16 v[48:63], v[128:131], v[64:67], 0
    s_add_u32 m0, m0, 4096
    s_add_u32 s42, s42, 4096
    buffer_load_dwordx4 v1, s[12:15], s42 offen offset:0 sc1 lds
    ds_read_b128 v[76:79], v7 offset:17408
    v_sub_f32 v11, 1.0, v6
    v_lshlrev_b32 v32, 16, v24
    s_waitcnt lgkmcnt(2)
    v_mfma_f32_32x32x16_bf16 v[48:63], v[132:135], v[68:71], v[48:63]
    buffer_load_dwordx4 v1, s[12:15], s42 offen offset:1024 sc1 lds
    s_waitcnt vmcnt(6)
    s_barrier
    ds_read_b128 v[80:83], v7 offset:2048
    v_and_b32 v33, 0xffff0000, v24
    v_lshlrev_b32 v34, 16, v25
    s_waitcnt lgkmcnt(2)
    v_mfma_f32_32x32x16_bf16 v[48:63], v[136:139], v[72:75], v[48:63]
    buffer_load_dwordx4 v1, s[12:15], s42 offen offset:2048 sc1 lds
    ds_read_b128 v[84:87], v7 offset:3072
    v_and_b32 v35, 0xffff0000, v25
    v_lshlrev_b32 v36, 16, v26
    s_waitcnt lgkmcnt(2)
    v_mfma_f32_32x32x16_bf16 v[48:63], v[140:143], v[76:79], v[48:63]
    buffer_load_dwordx4 v1, s[12:15], s42 offen offset:3072 sc1 lds
    ds_read_b128 v[88:91], v7 offset:18432
    v_and_b32 v37, 0xffff0000, v26
    v_lshlrev_b32 v38, 16, v27
    s_waitcnt lgkmcnt(2)
    v_mfma_f32_32x32x16_bf16 v[48:63], v[144:147], v[80:83], v[48:63]
    s_add_u32 m0, m0, 4096
    s_add_u32 s42, s42, 4096
    buffer_load_dwordx4 v1, s[12:15], s42 offen offset:0 sc1 lds
    ds_read_b128 v[92:95], v7 offset:19456
    v_and_b32 v39, 0xffff0000, v27
    v_lshlrev_b32 v40, 16, v28
    s_waitcnt lgkmcnt(2)
    v_mfma_f32_32x32x16_bf16 v[48:63], v[148:151], v[84:87], v[48:63]
    buffer_load_dwordx4 v1, s[12:15], s42 offen offset:1024 sc1 lds
    s_waitcnt vmcnt(6)
    s_barrier
    ds_read_b128 v[64:67], v7 offset:4096
    v_and_b32 v41, 0xffff0000, v28
    v_lshlrev_b32 v42, 16, v29
    s_waitcnt lgkmcnt(2)
    v_mfma_f32_32x32x16_bf16 v[48:63], v[152:155], v[88:91], v[48:63]
    buffer_load_dwordx4 v1, s[12:15], s42 offen offset:2048 sc1 lds
    ds_read_b128 v[68:71], v7 offset:5120
    v_and_b32 v43, 0xffff0000, v29
    v_lshlrev_b32 v44, 16, v30
    s_waitcnt lgkmcnt(2)
    v_mfma_f32_32x32x16_bf16 v[48:63], v[156:159], v[92:95], v[48:63]
    buffer_load_dwordx4 v1, s[12:15], s42 offen offset:3072 sc1 lds
    ds_read_b128 v[72:75], v7 offset:6144
    v_and_b32 v45, 0xffff0000, v30
    v_lshlrev_b32 v46, 16, v31
    s_waitcnt lgkmcnt(2)
    v_mfma_f32_32x32x16_bf16 v[48:63], v[160:163], v[64:67], v[48:63]
    ds_read_b128 v[76:79], v7 offset:7168
    v_and_b32 v47, 0xffff0000, v31
    v_mul_f32 v32, v32, v11
    s_waitcnt lgkmcnt(2)
    v_mfma_f32_32x32x16_bf16 v[48:63], v[164:167], v[68:71], v[48:63]
    ds_read_b128 v[80:83], v7 offset:20480
    v_mul_f32 v33, v33, v11
    v_mul_f32 v34, v34, v11
    s_waitcnt lgkmcnt(2)
    v_mfma_f32_32x32x16_bf16 v[48:63], v[168:171], v[72:75], v[48:63]
    ds_read_b128 v[84:87], v7 offset:21504
    v_mul_f32 v35, v35, v11
    v_mul_f32 v36, v36, v11
    s_waitcnt lgkmcnt(2)
    v_mfma_f32_32x32x16_bf16 v[48:63], v[172:175], v[76:79], v[48:63]
    ds_read_b128 v[88:91], v7 offset:22528
    v_mul_f32 v37, v37, v11
    v_mul_f32 v38, v38, v11
    s_waitcnt lgkmcnt(2)
    v_mfma_f32_32x32x16_bf16 v[48:63], v[176:179], v[80:83], v[48:63]
    ds_read_b128 v[92:95], v7 offset:23552
    v_mul_f32 v39, v39, v11
    v_mul_f32 v40, v40, v11
    s_waitcnt lgkmcnt(2)
    v_mfma_f32_32x32x16_bf16 v[48:63], v[180:183], v[84:87], v[48:63]
    s_waitcnt vmcnt(4)
    s_barrier
    ds_read_b128 v[64:67], v7 offset:8192
    v_mul_f32 v41, v41, v11
    v_mul_f32 v42, v42, v11
    s_waitcnt lgkmcnt(2)
    v_mfma_f32_32x32x16_bf16 v[48:63], v[184:187], v[88:91], v[48:63]
    ds_read_b128 v[68:71], v7 offset:9216
    v_mul_f32 v43, v43, v11
    v_mul_f32 v44, v44, v11
    s_waitcnt lgkmcnt(2)
    v_mfma_f32_32x32x16_bf16 v[48:63], v[188:191], v[92:95], v[48:63]
    ds_read_b128 v[72:75], v7 offset:10240
    v_mul_f32 v45, v45, v11
    v_mul_f32 v46, v46, v11
    s_waitcnt lgkmcnt(2)
    v_mfma_f32_32x32x16_bf16 v[48:63], v[192:195], v[64:67], v[48:63]
    ds_read_b128 v[76:79], v7 offset:11264
    v_mul_f32 v47, v47, v11
    s_mul_i32 s41, s46, 28672
    s_waitcnt lgkmcnt(2)
    v_mfma_f32_32x32x16_bf16 v[48:63], v[196:199], v[68:71], v[48:63]
    ds_read_b128 v[80:83], v7 offset:24576
    s_lshl_b32 s42, s47, 6
    s_add_u32 s41, s41, s42
    s_waitcnt lgkmcnt(2)
    v_mfma_f32_32x32x16_bf16 v[48:63], v[200:203], v[72:75], v[48:63]
    ds_read_b128 v[84:87], v7 offset:25600
    s_add_u32 s42, s41, 14336
    s_lshl_b32 s40, s3, 12
    s_waitcnt lgkmcnt(2)
    v_mfma_f32_32x32x16_bf16 v[48:63], v[204:207], v[76:79], v[48:63]
    ds_read_b128 v[88:91], v7 offset:26624
    s_add_u32 s40, s40, 32768
    v_mul_u32_u24 v19, 80, v2
    s_waitcnt lgkmcnt(2)
    v_mfma_f32_32x32x16_bf16 v[48:63], v[208:211], v[80:83], v[48:63]
    ds_read_b128 v[92:95], v7 offset:27648
    v_lshl_add_u32 v19, v3, 3, v19
    v_add_u32 v19, s40, v19
    s_waitcnt lgkmcnt(2)
    v_mfma_f32_32x32x16_bf16 v[48:63], v[212:215], v[84:87], v[48:63]
    s_waitcnt vmcnt(0)
    s_barrier
    ds_read_b128 v[64:67], v7 offset:12288
    v_lshrrev_b32 v21, 2, v0
    v_lshlrev_b32 v22, 4, v22
    s_waitcnt lgkmcnt(2)
    v_mfma_f32_32x32x16_bf16 v[48:63], v[216:219], v[88:91], v[48:63]
    ds_read_b128 v[68:71], v7 offset:13312
    v_mul_u32_u24 v20, 80, v21
    v_add3_u32 v20, v20, v22, s40
    s_waitcnt lgkmcnt(2)
    v_mfma_f32_32x32x16_bf16 v[48:63], v[220:223], v[92:95], v[48:63]
    ds_read_b128 v[72:75], v7 offset:14336
    v_mul_u32_u24 v18, 896, v21
    v_add_u32 v18, v18, v22
    s_waitcnt lgkmcnt(2)
    v_mfma_f32_32x32x16_bf16 v[48:63], v[224:227], v[64:67], v[48:63]
    ds_read_b128 v[76:79], v7 offset:15360
    s_waitcnt lgkmcnt(2)
    v_mfma_f32_32x32x16_bf16 v[48:63], v[228:231], v[68:71], v[48:63]
    ds_read_b128 v[80:83], v7 offset:28672
    s_waitcnt lgkmcnt(2)
    v_mfma_f32_32x32x16_bf16 v[48:63], v[232:235], v[72:75], v[48:63]
    ds_read_b128 v[84:87], v7 offset:29696
    s_waitcnt lgkmcnt(2)
    v_mfma_f32_32x32x16_bf16 v[48:63], v[236:239], v[76:79], v[48:63]
    ds_read_b128 v[88:91], v7 offset:30720
    s_waitcnt lgkmcnt(2)
    v_mfma_f32_32x32x16_bf16 v[48:63], v[240:243], v[80:83], v[48:63]
    ds_read_b128 v[92:95], v7 offset:31744
    s_waitcnt lgkmcnt(2)
    v_mfma_f32_32x32x16_bf16 v[48:63], v[244:247], v[84:87], v[48:63]
    s_waitcnt lgkmcnt(1)
    v_mfma_f32_32x32x16_bf16 v[48:63], v[248:251], v[88:91], v[48:63]
    s_waitcnt lgkmcnt(0)
    v_mfma_f32_32x32x16_bf16 v[48:63], v[252:255], v[92:95], v[48:63]
    s_nop 11
    v_fmac_f32 v32, v48, v6
    v_fmac_f32 v33, v49, v6
    v_fmac_f32 v34, v50, v6
    v_fmac_f32 v35, v51, v6
    v_fmac_f32 v36, v52, v6
    v_fmac_f32 v37, v53, v6
    v_fmac_f32 v38, v54, v6
    v_fmac_f32 v39, v55, v6
    v_cvt_pk_bf16_f32 v24, v32, v33
    v_cvt_pk_bf16_f32 v25, v34, v35
    v_cvt_pk_bf16_f32 v26, v36, v37
    v_cvt_pk_bf16_f32 v27, v38, v39
    ds_write_b64 v19, v[24:25] offset:0
    ds_write_b64 v19, v[26:27] offset:16
    v_fmac_f32 v40, v56, v6
    v_fmac_f32 v41, v57, v6
    v_fmac_f32 v42, v58, v6
    v_fmac_f32 v43, v59, v6
    v_fmac_f32 v44, v60, v6
    v_fmac_f32 v45, v61, v6
    v_fmac_f32 v46, v62, v6
    v_fmac_f32_e64 v47, v63, v6
    v_cvt_pk_bf16_f32 v28, v40, v41
    v_cvt_pk_bf16_f32 v29, v42, v43
    v_cvt_pk_bf16_f32 v30, v44, v45
    v_cvt_pk_bf16_f32 v31, v46, v47
    ds_write_b64 v19, v[28:29] offset:32
    ds_write_b64 v19, v[30:31] offset:48
    ds_read_b128 v[32:35], v20 offset:0
    ds_read_b128 v[36:39], v20 offset:1280
    s_waitcnt lgkmcnt(1)
    buffer_store_dwordx4 v[32:35], v18, s[56:59], s41 offen
    s_waitcnt lgkmcnt(0)
    buffer_store_dwordx4 v[36:39], v18, s[56:59], s42 offen
    s_endpgm
G_vk:
    s_waitcnt lgkmcnt(6)
    v_mfma_f32_32x32x16_bf16 v[56:71], v[120:123], v[40:43], 0
    s_add_u32 m0, s41, 65536
    ds_read_b128 v[132:135], v27 offset:0
    ds_read_b64_tr_b16 v[52:53], v32 offset:14336
    ds_read_b64_tr_b16 v[54:55], v32 offset:14848
    buffer_load_dwordx4 v4, s[4:7], s20 offen offset:0 lds
    s_waitcnt lgkmcnt(6)
    v_mfma_f32_32x32x16_bf16 v[56:71], v[124:127], v[44:47], v[56:71]
    ds_read_b128 v[136:139], v24 offset:16384
    ds_read_b64_tr_b16 v[40:41], v32 offset:24576
    ds_read_b64_tr_b16 v[42:43], v32 offset:25088
    buffer_load_dwordx4 v5, s[4:7], s20 offen offset:1024 lds
    s_waitcnt lgkmcnt(6)
    v_mfma_f32_32x32x16_bf16 v[56:71], v[128:131], v[48:51], v[56:71]
    s_add_u32 m0, s41, 73728
    ds_read_b128 v[140:143], v25 offset:16384
    ds_read_b64_tr_b16 v[44:45], v32 offset:26624
    ds_read_b64_tr_b16 v[46:47], v32 offset:27136
    buffer_load_dwordx4 v12, s[8:11], s27 offen offset:0 lds
    s_waitcnt lgkmcnt(6)
    v_mfma_f32_32x32x16_bf16 v[56:71], v[132:135], v[52:55], v[56:71]
    ds_read_b128 v[144:147], v26 offset:16384
    ds_read_b64_tr_b16 v[48:49], v32 offset:28672
    ds_read_b64_tr_b16 v[50:51], v32 offset:29184
    buffer_load_dwordx4 v13, s[8:11], s27 offen offset:1024 lds
    s_waitcnt lgkmcnt(6)
    v_mfma_f32_32x32x16_bf16 v[56:71], v[136:139], v[40:43], v[56:71]
    s_add_u32 m0, s41, 81920
    ds_read_b128 v[148:151], v27 offset:16384
    ds_read_b64_tr_b16 v[52:53], v32 offset:30720
    ds_read_b64_tr_b16 v[54:55], v32 offset:31232
    buffer_load_dwordx4 v4, s[4:7], s21 offen offset:0 lds
    s_waitcnt lgkmcnt(6)
    v_mfma_f32_32x32x16_bf16 v[56:71], v[140:143], v[44:47], v[56:71]
    s_nop 0
    buffer_load_dwordx4 v5, s[4:7], s21 offen offset:1024 lds
    s_add_u32 m0, s41, 90112
    s_nop 0
    buffer_load_dwordx4 v12, s[8:11], s32 offen offset:0 lds
    buffer_load_dwordx4 v13, s[8:11], s32 offen offset:1024 lds
    s_waitcnt vmcnt(8) lgkmcnt(0)
    s_barrier
    ds_read_b128 v[152:155], v24 offset:32768
    ds_read_b64_tr_b16 v[40:41], v32 offset:40960
    ds_read_b64_tr_b16 v[42:43], v32 offset:41472
    v_mfma_f32_32x32x16_bf16 v[56:71], v[144:147], v[48:51], v[56:71]
    s_add_u32 m0, s41, 0
    ds_read_b128 v[156:159], v25 offset:32768
    ds_read_b64_tr_b16 v[44:45], v32 offset:43008
    ds_read_b64_tr_b16 v[46:47], v32 offset:43520
    buffer_load_dwordx4 v4, s[4:7], s22 offen offset:0 lds
    v_mfma_f32_32x32x16_bf16 v[56:71], v[148:151], v[52:55], v[56:71]
    ds_read_b128 v[160:163], v26 offset:32768
    ds_read_b64_tr_b16 v[48:49], v32 offset:45056
    ds_read_b64_tr_b16 v[50:51], v32 offset:45568
    buffer_load_dwordx4 v5, s[4:7], s22 offen offset:1024 lds
    s_waitcnt lgkmcnt(6)
    v_mfma_f32_32x32x16_bf16 v[56:71], v[152:155], v[40:43], v[56:71]
    s_add_u32 m0, s41, 8192
    ds_read_b128 v[164:167], v27 offset:32768
    ds_read_b64_tr_b16 v[52:53], v32 offset:47104
    ds_read_b64_tr_b16 v[54:55], v32 offset:47616
    buffer_load_dwordx4 v12, s[8:11], s33 offen offset:0 lds
    s_waitcnt lgkmcnt(6)
    v_mfma_f32_32x32x16_bf16 v[56:71], v[156:159], v[44:47], v[56:71]
    ds_read_b128 v[168:171], v24 offset:49152
    ds_read_b64_tr_b16 v[40:41], v32 offset:57344
    ds_read_b64_tr_b16 v[42:43], v32 offset:57856
    buffer_load_dwordx4 v13, s[8:11], s33 offen offset:1024 lds
    s_waitcnt lgkmcnt(6)
    v_mfma_f32_32x32x16_bf16 v[56:71], v[160:163], v[48:51], v[56:71]
    s_add_u32 m0, s41, 16384
    ds_read_b128 v[172:175], v25 offset:49152
    ds_read_b64_tr_b16 v[44:45], v32 offset:59392
    ds_read_b64_tr_b16 v[46:47], v32 offset:59904
    buffer_load_dwordx4 v14, s[8:11], s23 offen offset:0 lds
    s_waitcnt lgkmcnt(6)
    v_mfma_f32_32x32x16_bf16 v[56:71], v[164:167], v[52:55], v[56:71]
    ds_read_b128 v[176:179], v26 offset:49152
    ds_read_b64_tr_b16 v[48:49], v32 offset:61440
    ds_read_b64_tr_b16 v[50:51], v32 offset:61952
    buffer_load_dwordx4 v15, s[8:11], s23 offen offset:1024 lds
    s_waitcnt lgkmcnt(6)
    v_mfma_f32_32x32x16_bf16 v[56:71], v[168:171], v[40:43], v[56:71]
    s_add_u32 m0, s41, 24576
    ds_read_b128 v[180:183], v27 offset:49152
    ds_read_b64_tr_b16 v[52:53], v32 offset:63488
    ds_read_b64_tr_b16 v[54:55], v32 offset:64000
    buffer_load_dwordx4 v14, s[8:11], s24 offen offset:0 lds
    s_waitcnt lgkmcnt(6)
    v_mfma_f32_32x32x16_bf16 v[56:71], v[172:175], v[44:47], v[56:71]
    s_nop 0
    buffer_load_dwordx4 v15, s[8:11], s24 offen offset:1024 lds
    s_waitcnt vmcnt(8) lgkmcnt(0)
    s_barrier
    ds_read_b128 v[184:187], v28 offset:0
    ds_read_b64_tr_b16 v[40:41], v33 offset:8192
    ds_read_b64_tr_b16 v[42:43], v33 offset:8704
    v_mfma_f32_32x32x16_bf16 v[56:71], v[176:179], v[48:51], v[56:71]
    s_add_u32 m0, s41, 32768
    ds_read_b128 v[188:191], v29 offset:0
    ds_read_b64_tr_b16 v[44:45], v33 offset:10240
    ds_read_b64_tr_b16 v[46:47], v33 offset:10752
    buffer_load_dwordx4 v14, s[8:11], s25 offen offset:0 lds
    v_mfma_f32_32x32x16_bf16 v[56:71], v[180:183], v[52:55], v[56:71]
    ds_read_b128 v[192:195], v30 offset:0
    ds_read_b64_tr_b16 v[48:49], v33 offset:12288
    ds_read_b64_tr_b16 v[50:51], v33 offset:12800
    buffer_load_dwordx4 v15, s[8:11], s25 offen offset:1024 lds
    s_waitcnt lgkmcnt(6)
    v_mfma_f32_32x32x16_bf16 v[56:71], v[184:187], v[40:43], v[56:71]
    s_add_u32 m0, s41, 40960
    ds_read_b128 v[196:199], v31 offset:0
    ds_read_b64_tr_b16 v[52:53], v33 offset:14336
    ds_read_b64_tr_b16 v[54:55], v33 offset:14848
    buffer_load_dwordx4 v14, s[8:11], s26 offen offset:0 lds
    s_waitcnt lgkmcnt(6)
    v_mfma_f32_32x32x16_bf16 v[56:71], v[188:191], v[44:47], v[56:71]
    ds_read_b128 v[200:203], v28 offset:16384
    ds_read_b64_tr_b16 v[40:41], v33 offset:24576
    ds_read_b64_tr_b16 v[42:43], v33 offset:25088
    buffer_load_dwordx4 v15, s[8:11], s26 offen offset:1024 lds
    s_waitcnt lgkmcnt(6)
    v_mfma_f32_32x32x16_bf16 v[56:71], v[192:195], v[48:51], v[56:71]
    s_add_u32 m0, s41, 49152
    ds_read_b128 v[204:207], v29 offset:16384
    ds_read_b64_tr_b16 v[44:45], v33 offset:26624
    ds_read_b64_tr_b16 v[46:47], v33 offset:27136
    buffer_load_dwordx4 v14, s[8:11], s27 offen offset:0 lds
    s_waitcnt lgkmcnt(6)
    v_mfma_f32_32x32x16_bf16 v[56:71], v[196:199], v[52:55], v[56:71]
    ds_read_b128 v[208:211], v30 offset:16384
    ds_read_b64_tr_b16 v[48:49], v33 offset:28672
    ds_read_b64_tr_b16 v[50:51], v33 offset:29184
    buffer_load_dwordx4 v15, s[8:11], s27 offen offset:1024 lds
    s_waitcnt lgkmcnt(6)
    v_mfma_f32_32x32x16_bf16 v[56:71], v[200:203], v[40:43], v[56:71]
    s_add_u32 m0, s41, 57344
    ds_read_b128 v[212:215], v31 offset:16384
    ds_read_b64_tr_b16 v[52:53], v33 offset:30720
    ds_read_b64_tr_b16 v[54:55], v33 offset:31232
    buffer_load_dwordx4 v14, s[8:11], s32 offen offset:0 lds
    s_waitcnt lgkmcnt(6)
    v_mfma_f32_32x32x16_bf16 v[56:71], v[204:207], v[44:47], v[56:71]
    s_nop 0
    buffer_load_dwordx4 v15, s[8:11], s32 offen offset:1024 lds
    s_waitcnt vmcnt(8) lgkmcnt(0)
    s_barrier
    ds_read_b128 v[216:219], v24 offset:0
    ds_read_b64_tr_b16 v[40:41], v32 offset:8192
    ds_read_b64_tr_b16 v[42:43], v32 offset:8704
    v_mfma_f32_32x32x16_bf16 v[56:71], v[208:211], v[48:51], v[56:71]
    s_add_u32 m0, s41, 65536
    ds_read_b128 v[220:223], v25 offset:0
    ds_read_b64_tr_b16 v[44:45], v32 offset:10240
    ds_read_b64_tr_b16 v[46:47], v32 offset:10752
    buffer_load_dwordx4 v14, s[8:11], s33 offen offset:0 lds
    v_mfma_f32_32x32x16_bf16 v[56:71], v[212:215], v[52:55], v[56:71]
    ds_read_b128 v[224:227], v26 offset:0
    ds_read_b64_tr_b16 v[48:49], v32 offset:12288
    ds_read_b64_tr_b16 v[50:51], v32 offset:12800
    buffer_load_dwordx4 v15, s[8:11], s33 offen offset:1024 lds
    s_waitcnt lgkmcnt(6)
    v_mfma_f32_32x32x16_bf16 v[56:71], v[216:219], v[40:43], v[56:71]
    s_add_u32 m0, s41, 73728
    ds_read_b128 v[228:231], v27 offset:0
    ds_read_b64_tr_b16 v[52:53], v32 offset:14336
    ds_read_b64_tr_b16 v[54:55], v32 offset:14848
    buffer_load_dwordx4 v16, s[8:11], s23 offen offset:0 lds
    s_waitcnt lgkmcnt(6)
    v_mfma_f32_32x32x16_bf16 v[56:71], v[220:223], v[44:47], v[56:71]
    ds_read_b64_tr_b16 v[40:41], v32 offset:16384
    ds_read_b64_tr_b16 v[42:43], v32 offset:16896
    buffer_load_dwordx4 v17, s[8:11], s23 offen offset:1024 lds
    s_waitcnt lgkmcnt(5)
    v_mfma_f32_32x32x16_bf16 v[56:71], v[224:227], v[48:51], v[56:71]
    s_add_u32 m0, s41, 81920
    ds_read_b64_tr_b16 v[44:45], v32 offset:18432
    ds_read_b64_tr_b16 v[46:47], v32 offset:18944
    buffer_load_dwordx4 v16, s[8:11], s24 offen offset:0 lds
    s_waitcnt lgkmcnt(4)
    v_mfma_f32_32x32x16_bf16 v[56:71], v[228:231], v[52:55], v[56:71]
    ds_read_b64_tr_b16 v[48:49], v32 offset:20480
    ds_read_b64_tr_b16 v[50:51], v32 offset:20992
    buffer_load_dwordx4 v17, s[8:11], s24 offen offset:1024 lds
    s_waitcnt lgkmcnt(4)
    v_mfma_f32_32x32x16_bf16 v[72:87], v[40:43], v[120:123], 0
    s_add_u32 m0, s41, 90112
    ds_read_b64_tr_b16 v[52:53], v32 offset:22528
    ds_read_b64_tr_b16 v[54:55], v32 offset:23040
    buffer_load_dwordx4 v16, s[8:11], s25 offen offset:0 lds
    s_waitcnt lgkmcnt(4)
    v_mfma_f32_32x32x16_bf16 v[72:87], v[44:47], v[124:127], v[72:87]
    ds_read_b64_tr_b16 v[40:41], v32 offset:24576
    ds_read_b64_tr_b16 v[42:43], v32 offset:25088
    buffer_load_dwordx4 v17, s[8:11], s25 offen offset:1024 lds
    s_waitcnt lgkmcnt(4)
    v_mfma_f32_32x32x16_bf16 v[72:87], v[48:51], v[128:131], v[72:87]
    ds_read_b64_tr_b16 v[44:45], v32 offset:26624
    ds_read_b64_tr_b16 v[46:47], v32 offset:27136
    s_waitcnt lgkmcnt(4)
    v_mfma_f32_32x32x16_bf16 v[72:87], v[52:55], v[132:135], v[72:87]
    ds_read_b64_tr_b16 v[48:49], v32 offset:28672
    ds_read_b64_tr_b16 v[50:51], v32 offset:29184
    v_cvt_pk_bf16_f32 v56, v56, v57
    v_cvt_pk_bf16_f32 v57, v58, v59
    v_cvt_pk_bf16_f32 v58, v60, v61
    s_waitcnt lgkmcnt(4)
    v_mfma_f32_32x32x16_bf16 v[72:87], v[40:43], v[136:139], v[72:87]
    ds_read_b64_tr_b16 v[52:53], v32 offset:30720
    ds_read_b64_tr_b16 v[54:55], v32 offset:31232
    v_cvt_pk_bf16_f32 v59, v62, v63
    v_cvt_pk_bf16_f32 v60, v64, v65
    v_cvt_pk_bf16_f32 v61, v66, v67
    s_waitcnt lgkmcnt(4)
    v_mfma_f32_32x32x16_bf16 v[72:87], v[44:47], v[140:143], v[72:87]
    s_waitcnt vmcnt(8) lgkmcnt(0)
    s_barrier
    ds_read_b64_tr_b16 v[40:41], v32 offset:32768
    ds_read_b64_tr_b16 v[42:43], v32 offset:33280
    v_cvt_pk_bf16_f32 v62, v68, v69
    v_cvt_pk_bf16_f32 v63, v70, v71
    v_permlane32_swap_b32 v56, v58
    v_mfma_f32_32x32x16_bf16 v[72:87], v[48:51], v[144:147], v[72:87]
    s_add_u32 m0, s41, 0
    ds_read_b64_tr_b16 v[44:45], v32 offset:34816
    ds_read_b64_tr_b16 v[46:47], v32 offset:35328
    buffer_load_dwordx4 v16, s[8:11], s26 offen offset:0 lds
    v_permlane32_swap_b32 v57, v59
    v_permlane32_swap_b32 v60, v62
    v_permlane32_swap_b32 v61, v63
    v_mfma_f32_32x32x16_bf16 v[72:87], v[52:55], v[148:151], v[72:87]
    ds_read_b64_tr_b16 v[48:49], v32 offset:36864
    ds_read_b64_tr_b16 v[50:51], v32 offset:37376
    buffer_load_dwordx4 v17, s[8:11], s26 offen offset:1024 lds
    s_waitcnt lgkmcnt(4)
    v_mfma_f32_32x32x16_bf16 v[72:87], v[40:43], v[152:155], v[72:87]
    s_add_u32 m0, s41, 8192
    ds_read_b64_tr_b16 v[52:53], v32 offset:38912
    ds_read_b64_tr_b16 v[54:55], v32 offset:39424
    buffer_load_dwordx4 v16, s[8:11], s27 offen offset:0 lds
    s_waitcnt lgkmcnt(4)
    v_mfma_f32_32x32x16_bf16 v[72:87], v[44:47], v[156:159], v[72:87]
    ds_read_b64_tr_b16 v[40:41], v32 offset:40960
    ds_read_b64_tr_b16 v[42:43], v32 offset:41472
    buffer_load_dwordx4 v17, s[8:11], s27 offen offset:1024 lds
    s_waitcnt lgkmcnt(4)
    v_mfma_f32_32x32x16_bf16 v[72:87], v[48:51], v[160:163], v[72:87]
    s_add_u32 m0, s41, 16384
    ds_read_b64_tr_b16 v[44:45], v32 offset:43008
    ds_read_b64_tr_b16 v[46:47], v32 offset:43520
    buffer_load_dwordx4 v16, s[8:11], s32 offen offset:0 lds
    s_waitcnt lgkmcnt(4)
    v_mfma_f32_32x32x16_bf16 v[72:87], v[52:55], v[164:167], v[72:87]
    ds_read_b64_tr_b16 v[48:49], v32 offset:45056
    ds_read_b64_tr_b16 v[50:51], v32 offset:45568
    buffer_load_dwordx4 v17, s[8:11], s32 offen offset:1024 lds
    s_waitcnt lgkmcnt(4)
    v_mfma_f32_32x32x16_bf16 v[72:87], v[40:43], v[168:171], v[72:87]
    s_add_u32 m0, s41, 24576
    ds_read_b64_tr_b16 v[52:53], v32 offset:47104
    ds_read_b64_tr_b16 v[54:55], v32 offset:47616
    buffer_load_dwordx4 v16, s[8:11], s33 offen offset:0 lds
    s_waitcnt lgkmcnt(4)
    v_mfma_f32_32x32x16_bf16 v[72:87], v[44:47], v[172:175], v[72:87]
    ds_read_b64_tr_b16 v[40:41], v32 offset:49152
    ds_read_b64_tr_b16 v[42:43], v32 offset:49664
    buffer_load_dwordx4 v17, s[8:11], s33 offen offset:1024 lds
    global_load_dwordx2 v[8:9], v10, s[48:49] sc1
    s_waitcnt lgkmcnt(4)
    v_mfma_f32_32x32x16_bf16 v[72:87], v[48:51], v[176:179], v[72:87]
    ds_read_b64_tr_b16 v[44:45], v32 offset:51200
    ds_read_b64_tr_b16 v[46:47], v32 offset:51712
    s_waitcnt lgkmcnt(4)
    v_mfma_f32_32x32x16_bf16 v[72:87], v[52:55], v[180:183], v[72:87]
    ds_read_b64_tr_b16 v[48:49], v32 offset:53248
    ds_read_b64_tr_b16 v[50:51], v32 offset:53760
    s_waitcnt lgkmcnt(4)
    v_mfma_f32_32x32x16_bf16 v[72:87], v[40:43], v[184:187], v[72:87]
    ds_read_b64_tr_b16 v[52:53], v32 offset:55296
    ds_read_b64_tr_b16 v[54:55], v32 offset:55808
    s_waitcnt lgkmcnt(4)
    v_mfma_f32_32x32x16_bf16 v[72:87], v[44:47], v[188:191], v[72:87]
    ds_read_b64_tr_b16 v[40:41], v32 offset:57344
    ds_read_b64_tr_b16 v[42:43], v32 offset:57856
    s_waitcnt lgkmcnt(4)
    v_mfma_f32_32x32x16_bf16 v[72:87], v[48:51], v[192:195], v[72:87]
    ds_read_b64_tr_b16 v[44:45], v32 offset:59392
    ds_read_b64_tr_b16 v[46:47], v32 offset:59904
    s_waitcnt lgkmcnt(4)
    v_mfma_f32_32x32x16_bf16 v[72:87], v[52:55], v[196:199], v[72:87]
    ds_read_b64_tr_b16 v[48:49], v32 offset:61440
    ds_read_b64_tr_b16 v[50:51], v32 offset:61952
    s_waitcnt lgkmcnt(4)
    v_mfma_f32_32x32x16_bf16 v[72:87], v[40:43], v[200:203], v[72:87]
    ds_read_b64_tr_b16 v[52:53], v32 offset:63488
    ds_read_b64_tr_b16 v[54:55], v32 offset:64000
    s_waitcnt lgkmcnt(4)
    v_mfma_f32_32x32x16_bf16 v[72:87], v[44:47], v[204:207], v[72:87]
    s_waitcnt vmcnt(9) lgkmcnt(0)
    s_barrier
    ds_read_b64_tr_b16 v[40:41], v33 offset:0
    ds_read_b64_tr_b16 v[42:43], v33 offset:512
    buffer_store_dwordx4 v[56:59], v34, s[12:15], s28 offen offset:0 sc1
    buffer_store_dwordx4 v[60:63], v35, s[12:15], s28 offen offset:1024 sc1
    v_mfma_f32_32x32x16_bf16 v[72:87], v[48:51], v[208:211], v[72:87]
    ds_read_b64_tr_b16 v[44:45], v33 offset:2048
    ds_read_b64_tr_b16 v[46:47], v33 offset:2560
    v_mfma_f32_32x32x16_bf16 v[72:87], v[52:55], v[212:215], v[72:87]
    ds_read_b64_tr_b16 v[48:49], v33 offset:4096
    ds_read_b64_tr_b16 v[50:51], v33 offset:4608
    s_waitcnt lgkmcnt(4)
    v_mfma_f32_32x32x16_bf16 v[72:87], v[40:43], v[216:219], v[72:87]
    ds_read_b64_tr_b16 v[52:53], v33 offset:6144
    ds_read_b64_tr_b16 v[54:55], v33 offset:6656
    s_waitcnt lgkmcnt(4)
    v_mfma_f32_32x32x16_bf16 v[72:87], v[44:47], v[220:223], v[72:87]
    ds_read_b64_tr_b16 v[40:41], v33 offset:8192
    ds_read_b64_tr_b16 v[42:43], v33 offset:8704
    s_waitcnt lgkmcnt(4)
    v_mfma_f32_32x32x16_bf16 v[72:87], v[48:51], v[224:227], v[72:87]
    ds_read_b64_tr_b16 v[44:45], v33 offset:10240
    ds_read_b64_tr_b16 v[46:47], v33 offset:10752
    s_waitcnt lgkmcnt(4)
    v_mfma_f32_32x32x16_bf16 v[72:87], v[52:55], v[228:231], v[72:87]
    ds_read_b64_tr_b16 v[48:49], v33 offset:12288
    ds_read_b64_tr_b16 v[50:51], v33 offset:12800
    s_branch G_q
A_ysp:
    s_mov_b32 s60, 0
A_y4:
    ds_read_b32 v19, v10 offset:61444
    s_add_u32 s60, s60, 1
    s_cmp_gt_u32 s60, 3200000
    s_cbranch_scc1 L_end
    s_waitcnt lgkmcnt(0)
    v_cmp_ne_u32 vcc, 4, v19
    s_cbranch_vccnz A_y4
    s_branch A_yok
A_norm:
    v_mov_b32 v18, v164
    v_mov_b32 v19, v164
    s_mov_b32 s46, 0x30800000
    s_mov_b32 s47, 0x4e800000
    v_permlane32_swap_b32 v18, v19
    s_mov_b32 exec_lo, 0
    v_mov_b32 v164, 0
    s_mov_b32 exec_lo, -1
    v_rcp_f32 v18, v19
    v_cmp_nge_f32 vcc, v19, s46
    v_cmp_nle_f32 s[66:67], v19, s47
    s_or_b64 vcc, vcc, s[66:67]
    s_branch A_store
L_aux:
    s_mov_b32 s47, 0
    s_or_b32 s41, s2, s3
    s_cmp_lg_u32 s41, 0
    s_cbranch_scc1 X_notok
    s_or_b32 s64, s64, 1
    v_mov_b32 v4, s64
    v_mov_b32 v5, s65
    v_mov_b32 v6, 0
    v_mov_b32 v7, 0
    s_mov_b64 exec, 1
    global_atomic_cmpswap_x2 v10, v[4:7], s[48:49] sc1
    s_mov_b64 exec, -1
    s_mov_b32 s47, 1
X_notok:
    s_lshr_b32 s36, s3, 1
    s_and_b32 s37, s3, 1
    s_lshr_b32 s38, s61, 6
    s_add_u32 s38, s38, s36
    v_mov_b32 v25, 61440
    s_lshl1_add_u32 s28, s35, s37
    s_mul_i32 s28, s28, 86016
    s_lshl_b32 s41, s36, 11
    s_add_u32 s28, s28, s41
    s_lshr_b32 s40, s33, 1
    s_xor_b32 s40, s40, s33
    s_and_b32 s40, s40, 1
    s_add_u32 s40, s40, 1
    s_mul_i32 s41, s40, 7
    s_add_u32 s41, s41, s34
    s_lshl_b32 s29, s41, 12
    s_add_u32 s29, s29, s28
    s_cmp_lt_u32 s41, 7
    s_cselect_b32 s29, 0x70000000, s29
    s_sub_u32 s40, 3, s40
    s_mul_i32 s41, s40, 7
    s_add_u32 s41, s41, s34
    s_lshl_b32 s30, s41, 12
    s_add_u32 s30, s30, s28
    s_cmp_lt_u32 s41, 7
    s_cselect_b32 s30, 0x70000000, s30
    s_mov_b32 s40, 0
    s_mul_i32 s41, s40, 7
    s_add_u32 s41, s41, s34
    s_lshl_b32 s31, s41, 12
    s_add_u32 s31, s31, s28
    s_cmp_lt_u32 s41, 7
    s_cselect_b32 s31, 0x70000000, s31
    s_mul_i32 s42, s36, 30720
    s_mul_i32 s43, s37, 8704
    s_add_u32 s43, s43, s42
    s_add_u32 s43, s43, 0
    s_add_u32 s46, s42, 22048
    s_lshl_b32 s41, s3, 2
    v_add_u32 v25, s41, v25
    v_mov_b32 v78, 0
    v_mov_b32 v79, 0
    v_mov_b32 v80, 0
    v_mov_b32 v81, 0
    v_mov_b32 v82, 0
    v_mov_b32 v83, 0
    v_mov_b32 v84, 0
    v_mov_b32 v85, 0
    v_mov_b32 v86, 0
    v_mov_b32 v87, 0
    v_mov_b32 v88, 0
    v_mov_b32 v89, 0
    v_mov_b32 v90, 0
    v_mov_b32 v91, 0
    v_mov_b32 v92, 0
    v_mov_b32 v93, 0
    v_add_u32 v26, s42, v1
    s_mov_b64 exec, 0x3fffffff
    ds_write_b128 v26, v[78:81] offset:17408
    s_mul_i32 s50, s37, 3328
    s_add_u32 s50, s50, s42
    s_mov_b64 exec, -1
    v_and_b32 v26, 15, v0
    v_lshlrev_b32 v26, 2, v26
    v_lshrrev_b32 v29, 4, v0
    v_and_b32 v27, 16, v0
    v_lshl_add_u32 v27, v27, 3, s43
    v_lshl_add_u32 v27, v3, 6, v27
    s_movk_i32 s41, 272
    s_mov_b32 s66, 0xb3a29180
    s_mov_b32 s67, 0xf7e6d5c4
    v_lshrrev_b64 v[30:31], v26, s[66:67]
    v_and_b32_e64 v30, 15, v30
    v_mad_u32_u24 v20, v30, s41, v27
    s_mov_b32 s66, 0x76543210
    s_mov_b32 s67, 0xab89efcd
    v_lshrrev_b64 v[30:31], v26, s[66:67]
    v_and_b32_e64 v30, 15, v30
    v_mad_u32_u24 v21, v30, s41, v27
    s_mov_b32 s66, 0xb9fd6420
    s_mov_b32 s67, 0xce8a1357
    v_lshrrev_b64 v[30:31], v26, s[66:67]
    v_and_b32_e64 v30, 15, v30
    v_mad_u32_u24 v22, v30, s41, v27
    s_mov_b32 s66, 0xea379d40
    s_mov_b32 s67, 0x518c26fb
    v_lshrrev_b64 v[30:31], v26, s[66:67]
    v_and_b32 v30, 15, v30
    v_mad_u32_u24 v23, v30, s41, v27
    s_lshl_b32 s41, s37, 10
    s_sub_u32 s41, 2047, s41
    v_sub_u32 v26, s41, v1
    v_cvt_f32_i32 v27, v26
    v_ffbh_u32 v30, v26
    v_sub_u32 v30, 24, v30
    v_med3_i32 v30, v30, 0, 3
    v_lshlrev_b32 v31, 23, v30
    v_add_u32 v31, 0x4b400000, v31
    v_lshlrev_b32 v32, 2, v31
    v_lshlrev_b32 v30, 9, v30
    v_sub_u32 v30, v30, v32
    v_add_f32 v240, v27, v31
    v_add_f32 v27, -1.0, v27
    v_lshl_add_u32 v240, v240, 2, v30
    v_ashrrev_i32 v28, 6, v240
    v_lshl_add_u32 v28, v28, 4, s50
    v_add_u32 v240, v240, v28
    v_add_f32 v241, v27, v31
    v_add_f32 v27, -1.0, v27
    v_lshl_add_u32 v241, v241, 2, v30
    v_ashrrev_i32 v28, 6, v241
    v_lshl_add_u32 v28, v28, 4, s50
    v_add_u32 v241, v241, v28
    v_add_f32 v242, v27, v31
    v_add_f32 v27, -1.0, v27
    v_lshl_add_u32 v242, v242, 2, v30
    v_ashrrev_i32 v28, 6, v242
    v_lshl_add_u32 v28, v28, 4, s50
    v_add_u32 v242, v242, v28
    v_add_f32 v243, v27, v31
    v_add_f32 v27, -1.0, v27
    v_lshl_add_u32 v243, v243, 2, v30
    v_ashrrev_i32 v28, 6, v243
    v_lshl_add_u32 v28, v28, 4, s50
    v_add_u32 v243, v243, v28
    v_add_f32 v244, v27, v31
    v_add_f32 v27, -1.0, v27
    v_lshl_add_u32 v244, v244, 2, v30
    v_ashrrev_i32 v28, 6, v244
    v_lshl_add_u32 v28, v28, 4, s50
    v_add_u32 v244, v244, v28
    v_add_f32 v245, v27, v31
    v_add_f32 v27, -1.0, v27
    v_lshl_add_u32 v245, v245, 2, v30
    v_ashrrev_i32 v28, 6, v245
    v_lshl_add_u32 v28, v28, 4, s50
    v_add_u32 v245, v245, v28
    v_add_f32 v246, v27, v31
    v_add_f32 v27, -1.0, v27
    v_lshl_add_u32 v246, v246, 2, v30
    v_ashrrev_i32 v28, 6, v246
    v_lshl_add_u32 v28, v28, 4, s50
    v_add_u32 v246, v246, v28
    v_add_f32 v247, v27, v31
    v_add_f32 v27, -1.0, v27
    v_lshl_add_u32 v247, v247, 2, v30
    v_ashrrev_i32 v28, 6, v247
    v_lshl_add_u32 v28, v28, 4, s50
    v_add_u32 v247, v247, v28
    v_add_f32 v248, v27, v31
    v_add_f32 v27, -1.0, v27
    v_lshl_add_u32 v248, v248, 2, v30
    v_ashrrev_i32 v28, 6, v248
    v_lshl_add_u32 v28, v28, 4, s50
    v_add_u32 v248, v248, v28
    v_add_f32 v249, v27, v31
    v_add_f32 v27, -1.0, v27
    v_lshl_add_u32 v249, v249, 2, v30
    v_ashrrev_i32 v28, 6, v249
    v_lshl_add_u32 v28, v28, 4, s50
    v_add_u32 v249, v249, v28
    v_add_f32 v250, v27, v31
    v_add_f32 v27, -1.0, v27
    v_lshl_add_u32 v250, v250, 2, v30
    v_ashrrev_i32 v28, 6, v250
    v_lshl_add_u32 v28, v28, 4, s50
    v_add_u32 v250, v250, v28
    v_add_f32 v251, v27, v31
    v_add_f32 v27, -1.0, v27
    v_lshl_add_u32 v251, v251, 2, v30
    v_ashrrev_i32 v28, 6, v251
    v_lshl_add_u32 v28, v28, 4, s50
    v_add_u32 v251, v251, v28
    v_add_f32 v252, v27, v31
    v_add_f32 v27, -1.0, v27
    v_lshl_add_u32 v252, v252, 2, v30
    v_ashrrev_i32 v28, 6, v252
    v_lshl_add_u32 v28, v28, 4, s50
    v_add_u32 v252, v252, v28
    v_add_f32 v253, v27, v31
    v_add_f32 v27, -1.0, v27
    v_lshl_add_u32 v253, v253, 2, v30
    v_ashrrev_i32 v28, 6, v253
    v_lshl_add_u32 v28, v28, 4, s50
    v_add_u32 v253, v253, v28
    v_add_f32 v254, v27, v31
    v_add_f32 v27, -1.0, v27
    v_lshl_add_u32 v254, v254, 2, v30
    v_ashrrev_i32 v28, 6, v254
    v_lshl_add_u32 v28, v28, 4, s50
    v_add_u32 v254, v254, v28
    v_add_f32 v255, v27, v31
    v_add_f32 v27, -1.0, v27
    v_lshl_add_u32 v255, v255, 2, v30
    v_ashrrev_i32 v28, 6, v255
    v_lshl_add_u32 v28, v28, 4, s50
    v_add_u32 v255, v255, v28
    v_subrev_u32 v26, 16, v26
    v_max_i32 v26, 1, v26
    v_ffbh_u32 v30, v26
    v_sub_u32 v30, 24, v30
    v_med3_i32 v30, v30, 0, 3
    v_lshlrev_b32 v31, 23, v30
    v_add_u32 v31, 0x4b400000, v31
    v_lshlrev_b32 v32, 2, v31
    v_lshlrev_b32 v30, 9, v30
    v_sub_u32 v30, v30, v32
    v_add_f32 v11, v27, v31
    v_lshl_add_u32 v11, v11, 2, v30
    v_ashrrev_i32 v28, 6, v11
    v_lshl_add_u32 v28, v28, 4, s50
    v_add_u32 v11, v11, v28
    v_and_b32 v30, 15, v0
    v_sub_u32 v26, 15, v30
    v_and_b32 v28, 1, v26
    v_mul_u32_u24 v28, 4158, v28
    v_lshl_add_u32 v26, v26, 1, v28
    s_lshl_b32 s41, s37, 8
    s_add_u32 s41, s41, s42
    v_lshl_add_u32 v28, v29, 4, s41
    v_add_u32 v6, v26, v28
    v_lshl_add_u32 v7, v30, 5, v28
    s_mov_b32 m0, s43
    s_waitcnt lgkmcnt(0)
    s_lshl_b32 s41, s36, 4
    s_lshr_b32 s44, s44, s41
    s_lshl_b32 s44, s44, 16
    s_lshr_b32 s45, s45, s41
    s_lshl_b32 s45, s45, 16
    v_mov_b32 v18, 0x3fb8aa3b
    v_mul_f32 v16, s44, v18
    v_exp_f32 v16, v16
    s_mov_b64 exec, 1
    v_mul_f32 v78, s45, 0.5
    s_mov_b64 exec, -1
    v_cvt_pk_bf16_f32 v16, v16, v16
    v_lshlrev_b32 v16, 16, v16
    v_add_f32 v17, v16, v16
    v_lshlrev_b32 v19, 7, v2
    s_lshl_b32 s51, s68, 15
    s_add_u32 s51, s51, 13660160
    s_waitcnt vmcnt(1)
    s_cmp_lg_u32 s47, 0
    s_cbranch_scc1 X_go
    s_waitcnt vmcnt(0)
X_go:
    v_lshlrev_b32 v26, 16, v12
    v_lshlrev_b32 v27, 16, v13
    v_mul_f32 v26, v26, v18
    v_exp_f32 v26, v26
    v_mul_f32 v27, v27, v16
    v_mul_f32 v28, 0.15915494, v27
    v_cvt_pk_bf16_f32 v26, v26, v26
    v_rndne_f32 v28, v28
    v_lshlrev_b32 v26, 16, v26
    v_fma_f32 v28, v27, 0.15915494, -v28
    v_fmamk_f32 v27, v27, 0x31dc9c88, v28
    v_mul_f32 v26, v26, v16
    v_mul_f32 v26, v26, -v18
    v_cos_f32 v34, v27
    v_sin_f32 v35, v27
    v_exp_f32 v28, v26
    v_mul_f32 v27, 0x41800000, v27
    v_mul_f32 v26, 0x41800000, v26
    v_mul_f32 v34, v34, v28
    v_mul_f32 v35, v35, v28
    v_cos_f32 v38, v27
    v_sin_f32 v40, v27
    v_exp_f32 v28, v26
    v_sub_f32 v36, 0, v35
    v_lshlrev_b32 v42, 16, v14
    v_lshlrev_b32 v43, 16, v15
    v_mul_f32 v38, v38, v28
    v_mul_f32 v40, v40, v28
    v_mul_f32 v42, v42, v17
    v_mul_f32 v43, v43, -v17
    v_sub_f32 v39, 0, v40
    v_pk_mul_f32 v[26:27], v[34:35], v[34:35] op_sel_hi:[1,0]
    v_cvt_pk_bf16_f32 v160, v42, v43
    v_pk_mul_f32 v[44:45], v[42:43], v[38:39] op_sel_hi:[1,0]
    v_pk_fma_f32 v[50:51], v[34:35], v[34:35], v[26:27] op_sel:[1,1,0] op_sel_hi:[0,1,1] neg_lo:[1,0,0]
    v_pk_fma_f32 v[44:45], v[42:43], v[38:39], v[44:45] op_sel:[1,1,0] op_sel_hi:[0,1,1] neg_lo:[1,0,0]
    v_pk_mul_f32 v[52:53], v[50:51], v[34:35] op_sel_hi:[1,0]
    v_cvt_pk_bf16_f32 v161, v44, v45
    v_pk_fma_f32 v[52:53], v[50:51], v[34:35], v[52:53] op_sel:[1,1,0] op_sel_hi:[0,1,1] neg_lo:[1,0,0]
    v_pk_mul_f32 v[42:43], v[44:45], v[38:39] op_sel_hi:[1,0]
    v_pk_mul_f32 v[26:27], v[50:51], v[50:51] op_sel_hi:[1,0]
    v_pk_fma_f32 v[42:43], v[44:45], v[38:39], v[42:43] op_sel:[1,1,0] op_sel_hi:[0,1,1] neg_lo:[1,0,0]
    v_pk_fma_f32 v[54:55], v[50:51], v[50:51], v[26:27] op_sel:[1,1,0] op_sel_hi:[0,1,1] neg_lo:[1,0,0]
    v_cvt_pk_bf16_f32 v162, v42, v43
    v_pk_mul_f32 v[44:45], v[42:43], v[38:39] op_sel_hi:[1,0]
    v_pk_mul_f32 v[56:57], v[54:55], v[34:35] op_sel_hi:[1,0]
    v_pk_fma_f32 v[44:45], v[42:43], v[38:39], v[44:45] op_sel:[1,1,0] op_sel_hi:[0,1,1] neg_lo:[1,0,0]
    v_pk_fma_f32 v[56:57], v[54:55], v[34:35], v[56:57] op_sel:[1,1,0] op_sel_hi:[0,1,1] neg_lo:[1,0,0]
    v_cvt_pk_bf16_f32 v163, v44, v45
    v_pk_mul_f32 v[26:27], v[52:53], v[52:53] op_sel_hi:[1,0]
    v_pk_mul_f32 v[42:43], v[44:45], v[38:39] op_sel_hi:[1,0]
    v_pk_fma_f32 v[58:59], v[52:53], v[52:53], v[26:27] op_sel:[1,1,0] op_sel_hi:[0,1,1] neg_lo:[1,0,0]
    v_pk_fma_f32 v[42:43], v[44:45], v[38:39], v[42:43] op_sel:[1,1,0] op_sel_hi:[0,1,1] neg_lo:[1,0,0]
    v_pk_mul_f32 v[60:61], v[58:59], v[34:35] op_sel_hi:[1,0]
    v_cvt_pk_bf16_f32 v164, v42, v43
    v_pk_mul_f32 v[44:45], v[42:43], v[38:39] op_sel_hi:[1,0]
    v_pk_fma_f32 v[60:61], v[58:59], v[34:35], v[60:61] op_sel:[1,1,0] op_sel_hi:[0,1,1] neg_lo:[1,0,0]
    v_pk_fma_f32 v[44:45], v[42:43], v[38:39], v[44:45] op_sel:[1,1,0] op_sel_hi:[0,1,1] neg_lo:[1,0,0]
    v_mov_b32 v144, 0x3f80
    v_cvt_pk_bf16_f32 v165, v44, v45
    v_cvt_pk_bf16_f32 v145, v34, v35
    v_pk_mul_f32 v[42:43], v[44:45], v[38:39] op_sel_hi:[1,0]
    v_cvt_pk_bf16_f32 v146, v50, v51
    v_pk_fma_f32 v[42:43], v[44:45], v[38:39], v[42:43] op_sel:[1,1,0] op_sel_hi:[0,1,1] neg_lo:[1,0,0]
    v_cvt_pk_bf16_f32 v147, v52, v53
    v_cvt_pk_bf16_f32 v166, v42, v43
    v_pk_mul_f32 v[44:45], v[42:43], v[38:39] op_sel_hi:[1,0]
    v_cvt_pk_bf16_f32 v148, v54, v55
    v_pk_fma_f32 v[44:45], v[42:43], v[38:39], v[44:45] op_sel:[1,1,0] op_sel_hi:[0,1,1] neg_lo:[1,0,0]
    v_cvt_pk_bf16_f32 v149, v56, v57
    v_cvt_pk_bf16_f32 v167, v44, v45
    v_cvt_pk_bf16_f32 v150, v58, v59
    v_pk_mul_f32 v[42:43], v[44:45], v[38:39] op_sel_hi:[1,0]
    v_cvt_pk_bf16_f32 v151, v60, v61
    v_pk_fma_f32 v[42:43], v[44:45], v[38:39], v[42:43] op_sel:[1,1,0] op_sel_hi:[0,1,1] neg_lo:[1,0,0]
    ds_write_addtid_b32 v144 offset:0
    ds_write_addtid_b32 v145 offset:2176
    ds_write_addtid_b32 v146 offset:272
    ds_write_addtid_b32 v147 offset:2448
    ds_write_addtid_b32 v148 offset:544
    ds_write_addtid_b32 v149 offset:2720
    ds_write_addtid_b32 v150 offset:816
    ds_write_addtid_b32 v151 offset:2992
    ds_write_addtid_b32 v160 offset:4352
    ds_write_addtid_b32 v161 offset:6528
    ds_write_addtid_b32 v162 offset:4624
    ds_write_addtid_b32 v163 offset:6800
    ds_write_addtid_b32 v164 offset:4896
    ds_write_addtid_b32 v165 offset:7072
    ds_write_addtid_b32 v166 offset:5168
    ds_write_addtid_b32 v167 offset:7344
    v_pk_mul_f32 v[26:27], v[54:55], v[54:55] op_sel_hi:[1,0]
    v_cvt_pk_bf16_f32 v168, v42, v43
    v_pk_fma_f32 v[62:63], v[54:55], v[54:55], v[26:27] op_sel:[1,1,0] op_sel_hi:[0,1,1] neg_lo:[1,0,0]
    v_pk_mul_f32 v[44:45], v[42:43], v[38:39] op_sel_hi:[1,0]
    v_pk_mul_f32 v[64:65], v[62:63], v[34:35] op_sel_hi:[1,0]
    v_pk_fma_f32 v[44:45], v[42:43], v[38:39], v[44:45] op_sel:[1,1,0] op_sel_hi:[0,1,1] neg_lo:[1,0,0]
    v_pk_fma_f32 v[64:65], v[62:63], v[34:35], v[64:65] op_sel:[1,1,0] op_sel_hi:[0,1,1] neg_lo:[1,0,0]
    v_cvt_pk_bf16_f32 v169, v44, v45
    v_pk_mul_f32 v[26:27], v[56:57], v[56:57] op_sel_hi:[1,0]
    v_pk_mul_f32 v[42:43], v[44:45], v[38:39] op_sel_hi:[1,0]
    v_pk_fma_f32 v[66:67], v[56:57], v[56:57], v[26:27] op_sel:[1,1,0] op_sel_hi:[0,1,1] neg_lo:[1,0,0]
    v_pk_fma_f32 v[42:43], v[44:45], v[38:39], v[42:43] op_sel:[1,1,0] op_sel_hi:[0,1,1] neg_lo:[1,0,0]
    v_pk_mul_f32 v[68:69], v[66:67], v[34:35] op_sel_hi:[1,0]
    v_cvt_pk_bf16_f32 v170, v42, v43
    v_pk_fma_f32 v[68:69], v[66:67], v[34:35], v[68:69] op_sel:[1,1,0] op_sel_hi:[0,1,1] neg_lo:[1,0,0]
    v_pk_mul_f32 v[44:45], v[42:43], v[38:39] op_sel_hi:[1,0]
    v_pk_mul_f32 v[26:27], v[58:59], v[58:59] op_sel_hi:[1,0]
    v_pk_fma_f32 v[44:45], v[42:43], v[38:39], v[44:45] op_sel:[1,1,0] op_sel_hi:[0,1,1] neg_lo:[1,0,0]
    v_pk_fma_f32 v[70:71], v[58:59], v[58:59], v[26:27] op_sel:[1,1,0] op_sel_hi:[0,1,1] neg_lo:[1,0,0]
    v_cvt_pk_bf16_f32 v171, v44, v45
    v_pk_mul_f32 v[72:73], v[70:71], v[34:35] op_sel_hi:[1,0]
    v_pk_mul_f32 v[42:43], v[44:45], v[38:39] op_sel_hi:[1,0]
    v_pk_fma_f32 v[72:73], v[70:71], v[34:35], v[72:73] op_sel:[1,1,0] op_sel_hi:[0,1,1] neg_lo:[1,0,0]
    v_pk_fma_f32 v[42:43], v[44:45], v[38:39], v[42:43] op_sel:[1,1,0] op_sel_hi:[0,1,1] neg_lo:[1,0,0]
    v_pk_mul_f32 v[26:27], v[60:61], v[60:61] op_sel_hi:[1,0]
    v_cvt_pk_bf16_f32 v172, v42, v43
    v_pk_fma_f32 v[74:75], v[60:61], v[60:61], v[26:27] op_sel:[1,1,0] op_sel_hi:[0,1,1] neg_lo:[1,0,0]
    v_pk_mul_f32 v[44:45], v[42:43], v[38:39] op_sel_hi:[1,0]
    v_pk_mul_f32 v[76:77], v[74:75], v[34:35] op_sel_hi:[1,0]
    v_pk_fma_f32 v[44:45], v[42:43], v[38:39], v[44:45] op_sel:[1,1,0] op_sel_hi:[0,1,1] neg_lo:[1,0,0]
    v_pk_fma_f32 v[76:77], v[74:75], v[34:35], v[76:77] op_sel:[1,1,0] op_sel_hi:[0,1,1] neg_lo:[1,0,0]
    v_cvt_pk_bf16_f32 v173, v44, v45
    v_cvt_pk_bf16_f32 v152, v62, v63
    v_pk_mul_f32 v[42:43], v[44:45], v[38:39] op_sel_hi:[1,0]
    v_cvt_pk_bf16_f32 v153, v64, v65
    v_pk_fma_f32 v[42:43], v[44:45], v[38:39], v[42:43] op_sel:[1,1,0] op_sel_hi:[0,1,1] neg_lo:[1,0,0]
    v_cvt_pk_bf16_f32 v154, v66, v67
    v_cvt_pk_bf16_f32 v174, v42, v43
    v_cvt_pk_bf16_f32 v155, v68, v69
    v_pk_mul_f32 v[44:45], v[42:43], v[38:39] op_sel_hi:[1,0]
    v_cvt_pk_bf16_f32 v156, v70, v71
    v_pk_fma_f32 v[44:45], v[42:43], v[38:39], v[44:45] op_sel:[1,1,0] op_sel_hi:[0,1,1] neg_lo:[1,0,0]
    v_cvt_pk_bf16_f32 v157, v72, v73
    v_cvt_pk_bf16_f32 v175, v44, v45
    v_cvt_pk_bf16_f32 v158, v74, v75
    v_pk_mul_f32 v[42:43], v[44:45], v[38:39] op_sel_hi:[1,0]
    v_cvt_pk_bf16_f32 v159, v76, v77
    v_pk_fma_f32 v[42:43], v[44:45], v[38:39], v[42:43] op_sel:[1,1,0] op_sel_hi:[0,1,1] neg_lo:[1,0,0]
    ds_write_addtid_b32 v152 offset:1088
    ds_write_addtid_b32 v153 offset:3264
    ds_write_addtid_b32 v154 offset:1360
    ds_write_addtid_b32 v155 offset:3536
    ds_write_addtid_b32 v156 offset:1632
    ds_write_addtid_b32 v157 offset:3808
    ds_write_addtid_b32 v158 offset:1904
    ds_write_addtid_b32 v159 offset:4080
    ds_write_addtid_b32 v168 offset:5440
    ds_write_addtid_b32 v169 offset:7616
    ds_write_addtid_b32 v170 offset:5712
    ds_write_addtid_b32 v171 offset:7888
    ds_write_addtid_b32 v172 offset:5984
    ds_write_addtid_b32 v173 offset:8160
    ds_write_addtid_b32 v174 offset:6256
    ds_write_addtid_b32 v175 offset:8432
    ds_read_b128 v[176:179], v20 offset:0
    ds_read_b128 v[180:183], v20 offset:16
    ds_read_b128 v[184:187], v20 offset:32
    ds_read_b128 v[188:191], v20 offset:48
    ds_read_b128 v[192:195], v20 offset:4352
    ds_read_b128 v[196:199], v20 offset:4368
    ds_read_b128 v[200:203], v20 offset:4384
    ds_read_b128 v[204:207], v20 offset:4400
    v_pk_mul_f32 v[30:31], v[38:39], v[38:39] op_sel_hi:[1,0]
    v_pk_fma_f32 v[38:39], v[38:39], v[38:39], v[30:31] op_sel:[1,1,0] op_sel_hi:[0,1,1] neg_lo:[1,0,0]
    v_pk_mul_f32 v[26:27], v[62:63], v[62:63] op_sel_hi:[1,0]
    v_cvt_pk_bf16_f32 v118, v42, v43
    v_pk_fma_f32 v[62:63], v[62:63], v[62:63], v[26:27] op_sel:[1,1,0] op_sel_hi:[0,1,1] neg_lo:[1,0,0]
    v_pk_mul_f32 v[44:45], v[42:43], v[38:39] op_sel_hi:[1,0]
    v_pk_mul_f32 v[30:31], v[64:65], v[64:65] op_sel_hi:[1,0]
    v_pk_fma_f32 v[44:45], v[42:43], v[38:39], v[44:45] op_sel:[1,1,0] op_sel_hi:[0,1,1] neg_lo:[1,0,0]
    v_pk_fma_f32 v[64:65], v[64:65], v[64:65], v[30:31] op_sel:[1,1,0] op_sel_hi:[0,1,1] neg_lo:[1,0,0]
    v_cvt_pk_bf16_f32 v119, v44, v45
    v_pk_mul_f32 v[26:27], v[66:67], v[66:67] op_sel_hi:[1,0]
    v_pk_mul_f32 v[42:43], v[44:45], v[38:39] op_sel_hi:[1,0]
    v_pk_fma_f32 v[66:67], v[66:67], v[66:67], v[26:27] op_sel:[1,1,0] op_sel_hi:[0,1,1] neg_lo:[1,0,0]
    v_pk_fma_f32 v[42:43], v[44:45], v[38:39], v[42:43] op_sel:[1,1,0] op_sel_hi:[0,1,1] neg_lo:[1,0,0]
    v_pk_mul_f32 v[30:31], v[68:69], v[68:69] op_sel_hi:[1,0]
    v_cvt_pk_bf16_f32 v120, v42, v43
    v_pk_fma_f32 v[68:69], v[68:69], v[68:69], v[30:31] op_sel:[1,1,0] op_sel_hi:[0,1,1] neg_lo:[1,0,0]
    v_pk_mul_f32 v[44:45], v[42:43], v[38:39] op_sel_hi:[1,0]
    v_pk_mul_f32 v[26:27], v[70:71], v[70:71] op_sel_hi:[1,0]
    v_pk_fma_f32 v[44:45], v[42:43], v[38:39], v[44:45] op_sel:[1,1,0] op_sel_hi:[0,1,1] neg_lo:[1,0,0]
    v_pk_fma_f32 v[70:71], v[70:71], v[70:71], v[26:27] op_sel:[1,1,0] op_sel_hi:[0,1,1] neg_lo:[1,0,0]
    v_cvt_pk_bf16_f32 v121, v44, v45
    v_pk_mul_f32 v[30:31], v[72:73], v[72:73] op_sel_hi:[1,0]
    v_pk_mul_f32 v[42:43], v[44:45], v[38:39] op_sel_hi:[1,0]
    v_pk_fma_f32 v[72:73], v[72:73], v[72:73], v[30:31] op_sel:[1,1,0] op_sel_hi:[0,1,1] neg_lo:[1,0,0]
    v_pk_fma_f32 v[42:43], v[44:45], v[38:39], v[42:43] op_sel:[1,1,0] op_sel_hi:[0,1,1] neg_lo:[1,0,0]
    v_pk_mul_f32 v[26:27], v[74:75], v[74:75] op_sel_hi:[1,0]
    v_cvt_pk_bf16_f32 v122, v42, v43
    v_pk_fma_f32 v[74:75], v[74:75], v[74:75], v[26:27] op_sel:[1,1,0] op_sel_hi:[0,1,1] neg_lo:[1,0,0]
    v_pk_mul_f32 v[44:45], v[42:43], v[38:39] op_sel_hi:[1,0]
    v_pk_mul_f32 v[30:31], v[76:77], v[76:77] op_sel_hi:[1,0]
    v_pk_fma_f32 v[44:45], v[42:43], v[38:39], v[44:45] op_sel:[1,1,0] op_sel_hi:[0,1,1] neg_lo:[1,0,0]
    s_waitcnt lgkmcnt(0)
    s_nop 0
    v_mfma_f32_16x16x32_bf16 v[78:81], v[176:179], v[192:195], v[78:81]
    v_pk_fma_f32 v[76:77], v[76:77], v[76:77], v[30:31] op_sel:[1,1,0] op_sel_hi:[0,1,1] neg_lo:[1,0,0]
    v_cvt_pk_bf16_f32 v123, v44, v45
    v_cvt_pk_bf16_f32 v94, v62, v63
    v_pk_mul_f32 v[42:43], v[44:45], v[38:39] op_sel_hi:[1,0]
    v_mfma_f32_16x16x32_bf16 v[78:81], v[180:183], v[196:199], v[78:81]
    v_cvt_pk_bf16_f32 v95, v64, v65
    v_pk_fma_f32 v[42:43], v[44:45], v[38:39], v[42:43] op_sel:[1,1,0] op_sel_hi:[0,1,1] neg_lo:[1,0,0]
    v_cvt_pk_bf16_f32 v96, v66, v67
    v_cvt_pk_bf16_f32 v124, v42, v43
    v_mfma_f32_16x16x32_bf16 v[78:81], v[184:187], v[200:203], v[78:81]
    v_cvt_pk_bf16_f32 v97, v68, v69
    v_pk_mul_f32 v[44:45], v[42:43], v[38:39] op_sel_hi:[1,0]
    v_cvt_pk_bf16_f32 v98, v70, v71
    v_pk_fma_f32 v[44:45], v[42:43], v[38:39], v[44:45] op_sel:[1,1,0] op_sel_hi:[0,1,1] neg_lo:[1,0,0]
    v_mfma_f32_16x16x32_bf16 v[78:81], v[188:191], v[204:207], v[78:81]
    v_cvt_pk_bf16_f32 v99, v72, v73
    v_cvt_pk_bf16_f32 v125, v44, v45
    v_cvt_pk_bf16_f32 v100, v74, v75
    v_pk_mul_f32 v[42:43], v[44:45], v[38:39] op_sel_hi:[1,0]
    v_cvt_pk_bf16_f32 v101, v76, v77
    v_pk_fma_f32 v[42:43], v[44:45], v[38:39], v[42:43] op_sel:[1,1,0] op_sel_hi:[0,1,1] neg_lo:[1,0,0]
    v_pk_mul_f32 v[30:31], v[38:39], v[38:39] op_sel_hi:[1,0]
    v_pk_fma_f32 v[38:39], v[38:39], v[38:39], v[30:31] op_sel:[1,1,0] op_sel_hi:[0,1,1] neg_lo:[1,0,0]
    v_pk_mul_f32 v[26:27], v[62:63], v[62:63] op_sel_hi:[1,0]
    v_cvt_pk_bf16_f32 v126, v42, v43
    v_pk_fma_f32 v[62:63], v[62:63], v[62:63], v[26:27] op_sel:[1,1,0] op_sel_hi:[0,1,1] neg_lo:[1,0,0]
    v_pk_mul_f32 v[44:45], v[42:43], v[38:39] op_sel_hi:[1,0]
    v_pk_mul_f32 v[30:31], v[64:65], v[64:65] op_sel_hi:[1,0]
    v_pk_fma_f32 v[44:45], v[42:43], v[38:39], v[44:45] op_sel:[1,1,0] op_sel_hi:[0,1,1] neg_lo:[1,0,0]
    v_pk_fma_f32 v[64:65], v[64:65], v[64:65], v[30:31] op_sel:[1,1,0] op_sel_hi:[0,1,1] neg_lo:[1,0,0]
    v_cvt_pk_bf16_f32 v127, v44, v45
    v_pk_mul_f32 v[26:27], v[66:67], v[66:67] op_sel_hi:[1,0]
    v_pk_mul_f32 v[42:43], v[44:45], v[38:39] op_sel_hi:[1,0]
    v_pk_fma_f32 v[66:67], v[66:67], v[66:67], v[26:27] op_sel:[1,1,0] op_sel_hi:[0,1,1] neg_lo:[1,0,0]
    v_pk_fma_f32 v[42:43], v[44:45], v[38:39], v[42:43] op_sel:[1,1,0] op_sel_hi:[0,1,1] neg_lo:[1,0,0]
    v_pk_mul_f32 v[30:31], v[68:69], v[68:69] op_sel_hi:[1,0]
    v_cvt_pk_bf16_f32 v128, v42, v43
    v_pk_fma_f32 v[68:69], v[68:69], v[68:69], v[30:31] op_sel:[1,1,0] op_sel_hi:[0,1,1] neg_lo:[1,0,0]
    v_pk_mul_f32 v[44:45], v[42:43], v[38:39] op_sel_hi:[1,0]
    v_pk_mul_f32 v[26:27], v[70:71], v[70:71] op_sel_hi:[1,0]
    v_pk_fma_f32 v[44:45], v[42:43], v[38:39], v[44:45] op_sel:[1,1,0] op_sel_hi:[0,1,1] neg_lo:[1,0,0]
    v_pk_fma_f32 v[70:71], v[70:71], v[70:71], v[26:27] op_sel:[1,1,0] op_sel_hi:[0,1,1] neg_lo:[1,0,0]
    v_cvt_pk_bf16_f32 v129, v44, v45
    v_pk_mul_f32 v[30:31], v[72:73], v[72:73] op_sel_hi:[1,0]
    v_pk_mul_f32 v[42:43], v[44:45], v[38:39] op_sel_hi:[1,0]
    v_pk_fma_f32 v[72:73], v[72:73], v[72:73], v[30:31] op_sel:[1,1,0] op_sel_hi:[0,1,1] neg_lo:[1,0,0]
    v_pk_fma_f32 v[42:43], v[44:45], v[38:39], v[42:43] op_sel:[1,1,0] op_sel_hi:[0,1,1] neg_lo:[1,0,0]
    v_pk_mul_f32 v[26:27], v[74:75], v[74:75] op_sel_hi:[1,0]
    v_cvt_pk_bf16_f32 v130, v42, v43
    v_pk_fma_f32 v[74:75], v[74:75], v[74:75], v[26:27] op_sel:[1,1,0] op_sel_hi:[0,1,1] neg_lo:[1,0,0]
    v_pk_mul_f32 v[44:45], v[42:43], v[38:39] op_sel_hi:[1,0]
    v_pk_mul_f32 v[30:31], v[76:77], v[76:77] op_sel_hi:[1,0]
    v_pk_fma_f32 v[44:45], v[42:43], v[38:39], v[44:45] op_sel:[1,1,0] op_sel_hi:[0,1,1] neg_lo:[1,0,0]
    v_pk_fma_f32 v[76:77], v[76:77], v[76:77], v[30:31] op_sel:[1,1,0] op_sel_hi:[0,1,1] neg_lo:[1,0,0]
    v_cvt_pk_bf16_f32 v131, v44, v45
    v_cvt_pk_bf16_f32 v102, v62, v63
    v_pk_mul_f32 v[42:43], v[44:45], v[38:39] op_sel_hi:[1,0]
    v_cvt_pk_bf16_f32 v103, v64, v65
    v_pk_fma_f32 v[42:43], v[44:45], v[38:39], v[42:43] op_sel:[1,1,0] op_sel_hi:[0,1,1] neg_lo:[1,0,0]
    v_cvt_pk_bf16_f32 v104, v66, v67
    v_cvt_pk_bf16_f32 v132, v42, v43
    v_cvt_pk_bf16_f32 v105, v68, v69
    v_pk_mul_f32 v[44:45], v[42:43], v[38:39] op_sel_hi:[1,0]
    v_cvt_pk_bf16_f32 v106, v70, v71
    v_pk_fma_f32 v[44:45], v[42:43], v[38:39], v[44:45] op_sel:[1,1,0] op_sel_hi:[0,1,1] neg_lo:[1,0,0]
    v_cvt_pk_bf16_f32 v107, v72, v73
    v_cvt_pk_bf16_f32 v133, v44, v45
    v_cvt_pk_bf16_f32 v108, v74, v75
    v_pk_mul_f32 v[42:43], v[44:45], v[38:39] op_sel_hi:[1,0]
    v_cvt_pk_bf16_f32 v109, v76, v77
    v_pk_fma_f32 v[42:43], v[44:45], v[38:39], v[42:43] op_sel:[1,1,0] op_sel_hi:[0,1,1] neg_lo:[1,0,0]
    v_pk_mul_f32 v[30:31], v[38:39], v[38:39] op_sel_hi:[1,0]
    v_pk_fma_f32 v[38:39], v[38:39], v[38:39], v[30:31] op_sel:[1,1,0] op_sel_hi:[0,1,1] neg_lo:[1,0,0]
    v_pk_mul_f32 v[26:27], v[62:63], v[62:63] op_sel_hi:[1,0]
    v_cvt_pk_bf16_f32 v134, v42, v43
    v_pk_mul_f32 v[44:45], v[42:43], v[38:39] op_sel_hi:[1,0]
    v_pk_fma_f32 v[62:63], v[62:63], v[62:63], v[26:27] op_sel:[1,1,0] op_sel_hi:[0,1,1] neg_lo:[1,0,0]
    v_pk_fma_f32 v[44:45], v[42:43], v[38:39], v[44:45] op_sel:[1,1,0] op_sel_hi:[0,1,1] neg_lo:[1,0,0]
    v_pk_mul_f32 v[30:31], v[64:65], v[64:65] op_sel_hi:[1,0]
    v_cvt_pk_bf16_f32 v135, v44, v45
    v_pk_fma_f32 v[64:65], v[64:65], v[64:65], v[30:31] op_sel:[1,1,0] op_sel_hi:[0,1,1] neg_lo:[1,0,0]
    v_pk_mul_f32 v[42:43], v[44:45], v[38:39] op_sel_hi:[1,0]
    v_pk_mul_f32 v[26:27], v[66:67], v[66:67] op_sel_hi:[1,0]
    v_pk_fma_f32 v[42:43], v[44:45], v[38:39], v[42:43] op_sel:[1,1,0] op_sel_hi:[0,1,1] neg_lo:[1,0,0]
    v_pk_fma_f32 v[66:67], v[66:67], v[66:67], v[26:27] op_sel:[1,1,0] op_sel_hi:[0,1,1] neg_lo:[1,0,0]
    v_cvt_pk_bf16_f32 v136, v42, v43
    v_pk_mul_f32 v[30:31], v[68:69], v[68:69] op_sel_hi:[1,0]
    v_pk_mul_f32 v[44:45], v[42:43], v[38:39] op_sel_hi:[1,0]
    v_pk_fma_f32 v[68:69], v[68:69], v[68:69], v[30:31] op_sel:[1,1,0] op_sel_hi:[0,1,1] neg_lo:[1,0,0]
    v_pk_fma_f32 v[44:45], v[42:43], v[38:39], v[44:45] op_sel:[1,1,0] op_sel_hi:[0,1,1] neg_lo:[1,0,0]
    v_pk_mul_f32 v[26:27], v[70:71], v[70:71] op_sel_hi:[1,0]
    v_cvt_pk_bf16_f32 v137, v44, v45
    v_pk_fma_f32 v[70:71], v[70:71], v[70:71], v[26:27] op_sel:[1,1,0] op_sel_hi:[0,1,1] neg_lo:[1,0,0]
    v_pk_mul_f32 v[42:43], v[44:45], v[38:39] op_sel_hi:[1,0]
    v_pk_mul_f32 v[30:31], v[72:73], v[72:73] op_sel_hi:[1,0]
    v_pk_fma_f32 v[42:43], v[44:45], v[38:39], v[42:43] op_sel:[1,1,0] op_sel_hi:[0,1,1] neg_lo:[1,0,0]
    v_pk_fma_f32 v[72:73], v[72:73], v[72:73], v[30:31] op_sel:[1,1,0] op_sel_hi:[0,1,1] neg_lo:[1,0,0]
    v_cvt_pk_bf16_f32 v138, v42, v43
    v_pk_mul_f32 v[26:27], v[74:75], v[74:75] op_sel_hi:[1,0]
    v_pk_mul_f32 v[44:45], v[42:43], v[38:39] op_sel_hi:[1,0]
    v_pk_fma_f32 v[74:75], v[74:75], v[74:75], v[26:27] op_sel:[1,1,0] op_sel_hi:[0,1,1] neg_lo:[1,0,0]
    v_pk_fma_f32 v[44:45], v[42:43], v[38:39], v[44:45] op_sel:[1,1,0] op_sel_hi:[0,1,1] neg_lo:[1,0,0]
    v_pk_mul_f32 v[30:31], v[76:77], v[76:77] op_sel_hi:[1,0]
    v_cvt_pk_bf16_f32 v139, v44, v45
    v_pk_fma_f32 v[76:77], v[76:77], v[76:77], v[30:31] op_sel:[1,1,0] op_sel_hi:[0,1,1] neg_lo:[1,0,0]
    v_pk_mul_f32 v[42:43], v[44:45], v[38:39] op_sel_hi:[1,0]
    v_cvt_pk_bf16_f32 v110, v62, v63
    v_pk_fma_f32 v[42:43], v[44:45], v[38:39], v[42:43] op_sel:[1,1,0] op_sel_hi:[0,1,1] neg_lo:[1,0,0]
    v_cvt_pk_bf16_f32 v111, v64, v65
    v_cvt_pk_bf16_f32 v140, v42, v43
    v_cvt_pk_bf16_f32 v112, v66, v67
    v_pk_mul_f32 v[44:45], v[42:43], v[38:39] op_sel_hi:[1,0]
    v_cvt_pk_bf16_f32 v113, v68, v69
    v_pk_fma_f32 v[44:45], v[42:43], v[38:39], v[44:45] op_sel:[1,1,0] op_sel_hi:[0,1,1] neg_lo:[1,0,0]
    v_cvt_pk_bf16_f32 v114, v70, v71
    v_cvt_pk_bf16_f32 v141, v44, v45
    v_cvt_pk_bf16_f32 v115, v72, v73
    v_pk_mul_f32 v[42:43], v[44:45], v[38:39] op_sel_hi:[1,0]
    v_cvt_pk_bf16_f32 v116, v74, v75
    v_pk_fma_f32 v[42:43], v[44:45], v[38:39], v[42:43] op_sel:[1,1,0] op_sel_hi:[0,1,1] neg_lo:[1,0,0]
    v_cvt_pk_bf16_f32 v117, v76, v77
    v_cvt_pk_bf16_f32 v142, v42, v43
    s_barrier
    buffer_store_dwordx4 v[0:3], v1, s[12:15], s30 offen offset:1024 sc1
    s_cmp_lg_u32 s3, 1
    s_cbranch_scc1 X_notick
    s_lshl_b32 s41, s68, 4
    s_add_u32 s41, s41, 128
    s_mov_b32 s33, 1
    s_atomic_add s33, s[48:49], s41 glc
X_notick:
    v_and_b32 v26, 0xffff0000, v12
    v_and_b32 v27, 0xffff0000, v13
    v_mul_f32 v26, v26, v18
    v_exp_f32 v26, v26
    v_mul_f32 v27, v27, v16
    v_mul_f32 v28, 0.15915494, v27
    v_cvt_pk_bf16_f32 v26, v26, v26
    v_rndne_f32 v28, v28
    v_lshlrev_b32 v26, 16, v26
    v_fma_f32 v28, v27, 0.15915494, -v28
    v_fmamk_f32 v27, v27, 0x31dc9c88, v28
    v_mul_f32 v26, v26, v16
    v_mul_f32 v26, v26, -v18
    v_cos_f32 v34, v27
    v_sin_f32 v35, v27
    v_exp_f32 v28, v26
    v_mul_f32 v27, 0x41800000, v27
    v_mul_f32 v26, 0x41800000, v26
    v_mul_f32 v34, v34, v28
    v_mul_f32 v35, v35, v28
    v_cos_f32 v38, v27
    v_sin_f32 v40, v27
    v_exp_f32 v28, v26
    v_sub_f32 v36, 0, v35
    v_and_b32 v42, 0xffff0000, v14
    v_and_b32 v43, 0xffff0000, v15
    v_mul_f32 v38, v38, v28
    v_mul_f32 v40, v40, v28
    v_mul_f32 v42, v42, v17
    v_mul_f32 v43, v43, -v17
    v_sub_f32 v39, 0, v40
    v_mul_f32 v26, v35, v35
    v_cvt_pk_bf16_f32 v184, v42, v43
    v_mul_f32 v44, v42, v38
    v_mul_f32_e64 v51, v34, v35 mul:2
    v_mul_f32 v45, v43, v38
    v_fma_f32 v50, v34, v34, -v26
    v_fmac_f32 v44, v43, v40
    v_fmac_f32 v45, v42, v39
    v_mul_f32 v52, v50, v34
    v_cvt_pk_bf16_f32 v185, v44, v45
    v_mul_f32 v53, v51, v34
    v_mul_f32 v42, v44, v38
    v_mul_f32 v43, v45, v38
    v_fmac_f32 v52, v51, v36
    v_fmac_f32 v42, v45, v40
    v_fmac_f32 v53, v50, v35
    v_fmac_f32 v43, v44, v39
    v_mul_f32 v26, v51, v51
    v_cvt_pk_bf16_f32 v186, v42, v43
    v_mul_f32 v44, v42, v38
    v_mul_f32_e64 v55, v50, v51 mul:2
    v_mul_f32 v45, v43, v38
    v_fma_f32 v54, v50, v50, -v26
    v_fmac_f32 v44, v43, v40
    v_fmac_f32 v45, v42, v39
    v_mul_f32 v56, v54, v34
    v_cvt_pk_bf16_f32 v187, v44, v45
    v_mul_f32 v57, v55, v34
    v_mul_f32 v42, v44, v38
    v_mul_f32 v43, v45, v38
    v_fmac_f32 v56, v55, v36
    v_fmac_f32 v42, v45, v40
    v_fmac_f32 v57, v54, v35
    v_fmac_f32 v43, v44, v39
    v_mul_f32 v26, v53, v53
    v_cvt_pk_bf16_f32 v188, v42, v43
    v_mul_f32 v44, v42, v38
    v_mul_f32_e64 v59, v52, v53 mul:2
    v_mul_f32 v45, v43, v38
    v_fma_f32 v58, v52, v52, -v26
    v_fmac_f32 v44, v43, v40
    v_fmac_f32 v45, v42, v39
    v_mul_f32 v60, v58, v34
    v_cvt_pk_bf16_f32 v189, v44, v45
    v_mul_f32 v61, v59, v34
    v_mul_f32 v42, v44, v38
    v_mul_f32 v43, v45, v38
    v_fmac_f32 v60, v59, v36
    v_fmac_f32 v42, v45, v40
    v_fmac_f32 v61, v58, v35
    v_fmac_f32 v43, v44, v39
    v_cvt_pk_bf16_f32 v145, v34, v35
    v_cvt_pk_bf16_f32 v190, v42, v43
    v_mul_f32 v44, v42, v38
    v_cvt_pk_bf16_f32 v146, v50, v51
    v_mul_f32 v45, v43, v38
    v_cvt_pk_bf16_f32 v147, v52, v53
    v_fmac_f32 v44, v43, v40
    v_fmac_f32 v45, v42, v39
    v_cvt_pk_bf16_f32 v148, v54, v55
    v_cvt_pk_bf16_f32 v191, v44, v45
    v_cvt_pk_bf16_f32 v149, v56, v57
    v_mul_f32 v42, v44, v38
    v_mul_f32 v43, v45, v38
    v_cvt_pk_bf16_f32 v150, v58, v59
    v_fmac_f32 v42, v45, v40
    v_cvt_pk_bf16_f32 v151, v60, v61
    v_fmac_f32 v43, v44, v39
    v_mul_f32 v26, v55, v55
    s_barrier
    v_cvt_pk_bf16_f32 v192, v42, v43
    v_mul_f32 v44, v42, v38
    v_mul_f32_e64 v63, v54, v55 mul:2
    v_mul_f32 v45, v43, v38
    v_fma_f32 v62, v54, v54, -v26
    v_fmac_f32 v44, v43, v40
    v_mul_f32 v64, v62, v34
    v_fmac_f32 v45, v42, v39
    v_mul_f32 v65, v63, v34
    v_cvt_pk_bf16_f32 v193, v44, v45
    v_fmac_f32 v64, v63, v36
    v_mul_f32 v42, v44, v38
    v_fmac_f32 v65, v62, v35
    v_mul_f32 v43, v45, v38
    v_mul_f32 v26, v57, v57
    v_fmac_f32 v42, v45, v40
    v_mul_f32_e64 v67, v56, v57 mul:2
    v_fmac_f32 v43, v44, v39
    v_fma_f32 v66, v56, v56, -v26
    v_cvt_pk_bf16_f32 v194, v42, v43
    v_mul_f32 v44, v42, v38
    v_mul_f32 v68, v66, v34
    v_mul_f32 v45, v43, v38
    v_mul_f32 v69, v67, v34
    v_fmac_f32 v44, v43, v40
    v_fmac_f32 v68, v67, v36
    v_fmac_f32 v45, v42, v39
    v_fmac_f32 v69, v66, v35
    v_cvt_pk_bf16_f32 v195, v44, v45
    v_mul_f32 v26, v59, v59
    v_mul_f32 v42, v44, v38
    v_mul_f32_e64 v71, v58, v59 mul:2
    v_mul_f32 v43, v45, v38
    v_fma_f32 v70, v58, v58, -v26
    v_fmac_f32 v42, v45, v40
    v_mul_f32 v72, v70, v34
    v_fmac_f32 v43, v44, v39
    v_mul_f32 v73, v71, v34
    v_cvt_pk_bf16_f32 v196, v42, v43
    v_mul_f32 v44, v42, v38
    v_fmac_f32 v72, v71, v36
    v_mul_f32 v45, v43, v38
    v_fmac_f32 v73, v70, v35
    v_fmac_f32 v44, v43, v40
    v_mul_f32 v26, v61, v61
    v_fmac_f32 v45, v42, v39
    v_mul_f32_e64 v75, v60, v61 mul:2
    v_cvt_pk_bf16_f32 v197, v44, v45
    v_fma_f32 v74, v60, v60, -v26
    v_mul_f32 v42, v44, v38
    v_mul_f32 v76, v74, v34
    v_mul_f32 v43, v45, v38
    v_mul_f32 v77, v75, v34
    v_fmac_f32 v42, v45, v40
    v_fmac_f32 v76, v75, v36
    v_fmac_f32 v43, v44, v39
    v_fmac_f32 v77, v74, v35
    v_cvt_pk_bf16_f32 v198, v42, v43
    v_mul_f32 v44, v42, v38
    v_cvt_pk_bf16_f32 v152, v62, v63
    v_mul_f32 v45, v43, v38
    v_cvt_pk_bf16_f32 v153, v64, v65
    v_fmac_f32 v44, v43, v40
    v_cvt_pk_bf16_f32 v154, v66, v67
    v_fmac_f32 v45, v42, v39
    v_cvt_pk_bf16_f32 v155, v68, v69
    v_cvt_pk_bf16_f32 v199, v44, v45
    v_cvt_pk_bf16_f32 v156, v70, v71
    v_mul_f32 v42, v44, v38
    v_cvt_pk_bf16_f32 v157, v72, v73
    v_mul_f32 v43, v45, v38
    v_cvt_pk_bf16_f32 v158, v74, v75
    v_fmac_f32 v42, v45, v40
    v_cvt_pk_bf16_f32 v159, v76, v77
    v_fmac_f32 v43, v44, v39
    v_mul_f32 v28, v39, v39
    v_mul_f32_e64 v39, v38, v39 mul:2
    v_fma_f32 v38, v38, v38, -v28
    v_sub_f32 v40, 0, v39
    v_mul_f32 v26, v63, v63
    v_cvt_pk_bf16_f32 v200, v42, v43
    v_mul_f32 v44, v42, v38
    v_mul_f32_e64 v63, v62, v63 mul:2
    v_mul_f32 v45, v43, v38
    v_fma_f32 v62, v62, v62, -v26
    v_fmac_f32 v44, v43, v40
    v_mul_f32 v27, v65, v65
    v_fmac_f32 v45, v42, v39
    v_mul_f32_e64 v65, v64, v65 mul:2
    v_cvt_pk_bf16_f32 v201, v44, v45
    v_mul_f32 v42, v44, v38
    v_fma_f32 v64, v64, v64, -v27
    v_mul_f32 v43, v45, v38
    v_mul_f32 v26, v67, v67
    v_fmac_f32 v42, v45, v40
    v_mul_f32_e64 v67, v66, v67 mul:2
    v_fmac_f32 v43, v44, v39
    v_fma_f32 v66, v66, v66, -v26
    v_cvt_pk_bf16_f32 v202, v42, v43
    v_mul_f32 v44, v42, v38
    s_barrier
    v_mul_f32 v27, v69, v69
    v_mul_f32 v45, v43, v38
    v_mul_f32_e64 v69, v68, v69 mul:2
    v_fmac_f32 v44, v43, v40
    v_fma_f32 v68, v68, v68, -v27
    v_fmac_f32 v45, v42, v39
    v_mul_f32 v26, v71, v71
    v_cvt_pk_bf16_f32 v203, v44, v45
    v_mul_f32 v42, v44, v38
    v_mul_f32_e64 v71, v70, v71 mul:2
    v_mul_f32 v43, v45, v38
    v_fma_f32 v70, v70, v70, -v26
    v_fmac_f32 v42, v45, v40
    v_mul_f32 v27, v73, v73
    v_fmac_f32 v43, v44, v39
    v_mul_f32_e64 v73, v72, v73 mul:2
    v_cvt_pk_bf16_f32 v204, v42, v43
    v_mul_f32 v44, v42, v38
    v_fma_f32 v72, v72, v72, -v27
    v_mul_f32 v45, v43, v38
    v_mul_f32 v26, v75, v75
    v_fmac_f32 v44, v43, v40
    v_mul_f32_e64 v75, v74, v75 mul:2
    v_fmac_f32 v45, v42, v39
    v_fma_f32 v74, v74, v74, -v26
    v_cvt_pk_bf16_f32 v205, v44, v45
    v_mul_f32 v42, v44, v38
    v_mul_f32 v27, v77, v77
    v_mul_f32 v43, v45, v38
    v_mul_f32_e64 v77, v76, v77 mul:2
    v_fmac_f32 v42, v45, v40
    v_fma_f32 v76, v76, v76, -v27
    v_fmac_f32 v43, v44, v39
    v_cvt_pk_bf16_f32 v160, v62, v63
    v_cvt_pk_bf16_f32 v206, v42, v43
    v_mul_f32 v44, v42, v38
    v_cvt_pk_bf16_f32 v161, v64, v65
    v_mul_f32 v45, v43, v38
    v_cvt_pk_bf16_f32 v162, v66, v67
    v_fmac_f32 v44, v43, v40
    v_cvt_pk_bf16_f32 v163, v68, v69
    v_fmac_f32 v45, v42, v39
    v_cvt_pk_bf16_f32 v164, v70, v71
    v_cvt_pk_bf16_f32 v207, v44, v45
    v_mul_f32 v42, v44, v38
    v_cvt_pk_bf16_f32 v165, v72, v73
    v_mul_f32 v43, v45, v38
    v_cvt_pk_bf16_f32 v166, v74, v75
    v_fmac_f32 v42, v45, v40
    v_cvt_pk_bf16_f32 v167, v76, v77
    v_fmac_f32 v43, v44, v39
    v_mul_f32 v28, v39, v39
    v_mul_f32_e64 v39, v38, v39 mul:2
    v_fma_f32 v38, v38, v38, -v28
    v_sub_f32 v40, 0, v39
    v_mul_f32 v26, v63, v63
    v_cvt_pk_bf16_f32 v208, v42, v43
    v_mul_f32 v44, v42, v38
    v_mul_f32_e64 v63, v62, v63 mul:2
    v_mul_f32 v45, v43, v38
    v_fma_f32 v62, v62, v62, -v26
    v_fmac_f32 v44, v43, v40
    v_mul_f32 v27, v65, v65
    v_fmac_f32 v45, v42, v39
    v_mul_f32_e64 v65, v64, v65 mul:2
    v_cvt_pk_bf16_f32 v209, v44, v45
    v_mul_f32 v42, v44, v38
    v_fma_f32 v64, v64, v64, -v27
    v_mul_f32 v43, v45, v38
    v_mul_f32 v26, v67, v67
    v_fmac_f32 v42, v45, v40
    v_mul_f32_e64 v67, v66, v67 mul:2
    v_fmac_f32 v43, v44, v39
    v_fma_f32 v66, v66, v66, -v26
    v_cvt_pk_bf16_f32 v210, v42, v43
    v_mul_f32 v44, v42, v38
    v_mul_f32 v27, v69, v69
    v_mul_f32 v45, v43, v38
    v_mul_f32_e64 v69, v68, v69 mul:2
    v_fmac_f32 v44, v43, v40
    v_fma_f32 v68, v68, v68, -v27
    v_fmac_f32 v45, v42, v39
    v_mul_f32 v26, v71, v71
    v_cvt_pk_bf16_f32 v211, v44, v45
    v_mul_f32 v42, v44, v38
    v_mul_f32_e64 v71, v70, v71 mul:2
    v_mul_f32 v43, v45, v38
    v_fma_f32 v70, v70, v70, -v26
    v_fmac_f32 v42, v45, v40
    v_mul_f32 v27, v73, v73
    s_barrier
    global_load_dwordx2 v[8:9], v10, s[48:49] sc1
    v_fmac_f32 v43, v44, v39
    v_mul_f32_e64 v73, v72, v73 mul:2
    v_cvt_pk_bf16_f32 v212, v42, v43
    v_mul_f32 v44, v42, v38
    v_fma_f32 v72, v72, v72, -v27
    v_mul_f32 v45, v43, v38
    v_mul_f32 v26, v75, v75
    v_fmac_f32 v44, v43, v40
    v_mul_f32_e64 v75, v74, v75 mul:2
    v_fmac_f32 v45, v42, v39
    v_fma_f32 v74, v74, v74, -v26
    v_cvt_pk_bf16_f32 v213, v44, v45
    v_mul_f32 v42, v44, v38
    v_mul_f32 v27, v77, v77
    v_mul_f32 v43, v45, v38
    v_mul_f32_e64 v77, v76, v77 mul:2
    v_fmac_f32 v42, v45, v40
    v_fma_f32 v76, v76, v76, -v27
    v_fmac_f32 v43, v44, v39
    v_cvt_pk_bf16_f32 v168, v62, v63
    v_cvt_pk_bf16_f32 v214, v42, v43
    v_mul_f32 v44, v42, v38
    v_cvt_pk_bf16_f32 v169, v64, v65
    v_mul_f32 v45, v43, v38
    v_cvt_pk_bf16_f32 v170, v66, v67
    v_fmac_f32 v44, v43, v40
    v_cvt_pk_bf16_f32 v171, v68, v69
    v_fmac_f32 v45, v42, v39
    v_cvt_pk_bf16_f32 v172, v70, v71
    v_cvt_pk_bf16_f32 v215, v44, v45
    v_mul_f32 v42, v44, v38
    v_cvt_pk_bf16_f32 v173, v72, v73
    v_mul_f32 v43, v45, v38
    v_cvt_pk_bf16_f32 v174, v74, v75
    v_fmac_f32 v42, v45, v40
    v_cvt_pk_bf16_f32 v175, v76, v77
    v_fmac_f32 v43, v44, v39
    v_mul_f32 v28, v39, v39
    v_mul_f32_e64 v39, v38, v39 mul:2
    v_fma_f32 v38, v38, v38, -v28
    v_sub_f32 v40, 0, v39
    v_mul_f32 v26, v63, v63
    v_cvt_pk_bf16_f32 v216, v42, v43
    v_mul_f32 v44, v42, v38
    v_mul_f32_e64 v63, v62, v63 mul:2
    v_mul_f32 v45, v43, v38
    v_fma_f32 v62, v62, v62, -v26
    v_fmac_f32 v44, v43, v40
    v_mul_f32 v27, v65, v65
    v_fmac_f32 v45, v42, v39
    v_cvt_pk_bf16_f32 v217, v44, v45
    v_mul_f32_e64 v65, v64, v65 mul:2
    v_mul_f32 v42, v44, v38
    v_fma_f32 v64, v64, v64, -v27
    v_mul_f32 v43, v45, v38
    v_mul_f32 v26, v67, v67
    v_fmac_f32 v42, v45, v40
    v_mul_f32_e64 v67, v66, v67 mul:2
    v_fmac_f32 v43, v44, v39
    v_cvt_pk_bf16_f32 v218, v42, v43
    s_barrier
    v_fma_f32 v66, v66, v66, -v26
    v_mul_f32 v44, v42, v38
    v_mul_f32 v27, v69, v69
    v_mul_f32 v45, v43, v38
    v_mul_f32_e64 v69, v68, v69 mul:2
    v_fmac_f32 v44, v43, v40
    v_fmac_f32 v45, v42, v39
    v_fma_f32 v68, v68, v68, -v27
    v_cvt_pk_bf16_f32 v219, v44, v45
    v_mul_f32 v26, v71, v71
    v_mul_f32 v42, v44, v38
    v_mul_f32_e64 v71, v70, v71 mul:2
    v_mul_f32 v43, v45, v38
    v_fma_f32 v70, v70, v70, -v26
    v_fmac_f32 v42, v45, v40
    v_fmac_f32 v43, v44, v39
    v_mul_f32 v27, v73, v73
    v_cvt_pk_bf16_f32 v220, v42, v43
    v_mul_f32_e64 v73, v72, v73 mul:2
    v_mul_f32 v44, v42, v38
    v_fma_f32 v72, v72, v72, -v27
    v_mul_f32 v45, v43, v38
    v_fmac_f32 v44, v43, v40
    v_mul_f32 v26, v75, v75
    v_fmac_f32 v45, v42, v39
    v_mul_f32_e64 v75, v74, v75 mul:2
    v_cvt_pk_bf16_f32 v221, v44, v45
    v_fma_f32 v74, v74, v74, -v26
    v_mul_f32 v42, v44, v38
    v_mul_f32 v27, v77, v77
    s_waitcnt vmcnt(0)
    s_barrier
    s_cmp_lg_u32 s3, 0
    s_cbranch_scc1 X_nopA
    s_mov_b32 exec_hi, 0
    buffer_load_dwordx2 v[4:5], v19, s[12:15], s51 offen sc1
    s_mov_b32 exec_hi, -1
X_nopA:
    s_cmp_eq_u32 s3, 0
    s_cselect_b32 s47, 1, 0
    v_mul_f32 v43, v45, v38
    v_fmac_f32 v42, v45, v40
    v_mul_f32_e64 v77, v76, v77 mul:2
    v_fmac_f32 v43, v44, v39
    v_fma_f32 v76, v76, v76, -v27
    v_cvt_pk_bf16_f32 v222, v42, v43
    v_cvt_pk_bf16_f32 v176, v62, v63
    v_mul_f32 v44, v42, v38
    v_mul_f32 v45, v43, v38
    v_cvt_pk_bf16_f32 v177, v64, v65
    v_fmac_f32 v44, v43, v40
    v_cvt_pk_bf16_f32 v178, v66, v67
    v_fmac_f32 v45, v42, v39
    v_cvt_pk_bf16_f32 v179, v68, v69
    v_cvt_pk_bf16_f32 v223, v44, v45
    v_cvt_pk_bf16_f32 v180, v70, v71
    v_mul_f32 v42, v44, v38
    v_mul_f32 v43, v45, v38
    v_cvt_pk_bf16_f32 v181, v72, v73
    v_fmac_f32 v42, v45, v40
    v_cvt_pk_bf16_f32 v182, v74, v75
    v_fmac_f32 v43, v44, v39
    v_cvt_pk_bf16_f32 v183, v76, v77
    s_barrier
    s_setprio 1
    s_waitcnt lgkmcnt(0)
    s_cmp_lg_u32 s3, 1
    s_cbranch_scc1 X_norole
    s_and_b32 s41, s33, 31
    s_lshl_b32 s69, s68, 5
    s_add_u32 s41, s41, s69
    s_add_u32 s41, s41, 1
    v_mov_b32 v24, s41
    ds_write_b32 v10, v24 offset:61448
X_norole:
    s_waitcnt vmcnt(0)
    s_mov_b32 s60, 0
X_tok:
    v_readfirstlane_b32 s62, v8
    v_readfirstlane_b32 s63, v9
    s_cmp_lg_u64 s[62:63], 0
    s_cbranch_scc1 X_tok_ok
    global_load_dwordx2 v[8:9], v10, s[48:49] sc1
    s_add_u32 s60, s60, 1
    s_cmp_gt_u32 s60, 400000
    s_cbranch_scc1 L_end
    s_waitcnt vmcnt(0)
    s_branch X_tok
X_tok_ok:
    s_cmp_eq_u32 s47, 0
    s_cbranch_scc1 X_nopC
    s_waitcnt vmcnt(0)
    v_cmp_ne_u64 vcc, v[4:5], s[62:63]
    s_cmp_eq_u32 vcc_lo, 0
    s_cbranch_scc0 X_repC
    s_mov_b32 s47, 0
    s_lshl_b32 s44, s38, 12
    s_mov_b32 m0, 17888
    s_add_u32 s44, s44, 6291456
    buffer_load_dwordx4 v1, s[12:15], s44 offen offset:0 sc1 lds
    buffer_load_dwordx4 v1, s[12:15], s44 offen offset:1024 sc1 lds
    buffer_load_dwordx4 v1, s[12:15], s44 offen offset:2048 sc1 lds
    buffer_load_dwordx4 v1, s[12:15], s44 offen offset:3072 sc1 lds
    s_mov_b32 m0, 48608
    s_add_u32 s44, s44, 4096
    buffer_load_dwordx4 v1, s[12:15], s44 offen offset:0 sc1 lds
    buffer_load_dwordx4 v1, s[12:15], s44 offen offset:1024 sc1 lds
    buffer_load_dwordx4 v1, s[12:15], s44 offen offset:2048 sc1 lds
    buffer_load_dwordx4 v1, s[12:15], s44 offen offset:3072 sc1 lds
    s_mov_b32 m0, s43
    s_branch X_nopC
X_repC:
    s_cmp_lg_u32 s3, 0
    s_cbranch_scc1 X_nopC
    s_mov_b32 exec_hi, 0
    buffer_load_dwordx2 v[4:5], v19, s[12:15], s51 offen sc1
    s_mov_b32 exec_hi, -1
X_nopC:
    v_cvt_pk_bf16_f32 v33, v42, v43
    ds_write_addtid_b32 v94 offset:3536
    ds_write_addtid_b32 v95 offset:3264
    ds_write_addtid_b32 v96 offset:4080
    ds_write_addtid_b32 v97 offset:3808
    ds_write_addtid_b32 v98 offset:2448
    ds_write_addtid_b32 v99 offset:2176
    ds_write_addtid_b32 v100 offset:2992
    ds_write_addtid_b32 v101 offset:2720
    ds_write_addtid_b32 v118 offset:4352
    ds_write_addtid_b32 v119 offset:6528
    ds_write_addtid_b32 v120 offset:4624
    ds_write_addtid_b32 v121 offset:6800
    ds_write_addtid_b32 v122 offset:4896
    ds_write_addtid_b32 v123 offset:7072
    ds_write_addtid_b32 v124 offset:5168
    ds_write_addtid_b32 v125 offset:7344
    ds_write_addtid_b32 v126 offset:5440
    ds_write_addtid_b32 v127 offset:7616
    ds_write_addtid_b32 v128 offset:5712
    ds_write_addtid_b32 v129 offset:7888
    ds_write_addtid_b32 v130 offset:5984
    ds_write_addtid_b32 v131 offset:8160
    ds_write_addtid_b32 v132 offset:6256
    ds_write_addtid_b32 v133 offset:8432
    ds_read_b128 v[46:49], v21 offset:0
    ds_read_b128 v[50:53], v21 offset:16
    ds_read_b128 v[54:57], v21 offset:32
    ds_read_b128 v[58:61], v21 offset:48
    ds_read_b128 v[224:227], v20 offset:4352
    ds_read_b128 v[228:231], v20 offset:4368
    ds_read_b128 v[232:235], v20 offset:4384
    ds_read_b128 v[236:239], v20 offset:4400
    ds_write_addtid_b32 v102 offset:1904
    ds_write_addtid_b32 v103 offset:1360
    ds_write_addtid_b32 v104 offset:816
    ds_write_addtid_b32 v105 offset:272
    ds_write_addtid_b32 v106 offset:2720
    ds_write_addtid_b32 v107 offset:2176
    ds_write_addtid_b32 v108 offset:3808
    ds_write_addtid_b32 v109 offset:3264
    ds_read_b128 v[94:97], v22 offset:0
    ds_read_b128 v[98:101], v22 offset:16
    ds_read_b128 v[102:105], v22 offset:32
    ds_read_b128 v[106:109], v22 offset:48
    ds_write_addtid_b32 v110 offset:2992
    ds_write_addtid_b32 v111 offset:4080
    ds_write_addtid_b32 v112 offset:1632
    ds_write_addtid_b32 v113 offset:544
    ds_write_addtid_b32 v114 offset:3264
    ds_write_addtid_b32 v115 offset:2176
    ds_write_addtid_b32 v116 offset:272
    ds_write_addtid_b32 v117 offset:1360
    s_waitcnt lgkmcnt(15)
    v_mfma_f32_16x16x32_bf16 v[82:85], v[46:49], v[224:227], v[82:85]
    v_mfma_f32_16x16x32_bf16 v[82:85], v[50:53], v[228:231], v[82:85]
    v_mfma_f32_16x16x32_bf16 v[82:85], v[54:57], v[232:235], v[82:85]
    v_mfma_f32_16x16x32_bf16 v[82:85], v[58:61], v[236:239], v[82:85]
    ds_write_addtid_b32 v134 offset:4352
    ds_write_addtid_b32 v135 offset:6528
    ds_write_addtid_b32 v136 offset:4624
    ds_write_addtid_b32 v137 offset:6800
    ds_write_addtid_b32 v138 offset:4896
    ds_write_addtid_b32 v139 offset:7072
    ds_write_addtid_b32 v140 offset:5168
    ds_write_addtid_b32 v141 offset:7344
    ds_write_addtid_b32 v142 offset:5440
    s_waitcnt lgkmcnt(15)
    v_mfma_f32_16x16x32_bf16 v[86:89], v[94:97], v[224:227], v[86:89]
    v_mfma_f32_16x16x32_bf16 v[86:89], v[98:101], v[228:231], v[86:89]
    v_mfma_f32_16x16x32_bf16 v[86:89], v[102:105], v[232:235], v[86:89]
    v_mfma_f32_16x16x32_bf16 v[86:89], v[106:109], v[236:239], v[86:89]
    ds_read_b128 v[46:49], v23 offset:0
    ds_read_b128 v[50:53], v23 offset:16
    ds_read_b128 v[54:57], v23 offset:32
    ds_read_b128 v[58:61], v23 offset:48
    ds_read_b128 v[118:121], v20 offset:4352
    ds_read_b128 v[122:125], v20 offset:4368
    ds_read_b128 v[126:129], v20 offset:4384
    ds_read_b128 v[130:133], v20 offset:4400
    ds_write_addtid_b32 v145 offset:2176
    ds_write_addtid_b32 v146 offset:272
    ds_write_addtid_b32 v147 offset:2448
    ds_write_addtid_b32 v148 offset:544
    ds_write_addtid_b32 v149 offset:2720
    ds_write_addtid_b32 v150 offset:816
    ds_write_addtid_b32 v151 offset:2992
    ds_write_addtid_b32 v152 offset:1088
    ds_write_addtid_b32 v153 offset:3264
    ds_write_addtid_b32 v154 offset:1360
    ds_write_addtid_b32 v155 offset:3536
    ds_write_addtid_b32 v156 offset:1632
    ds_write_addtid_b32 v157 offset:3808
    ds_write_addtid_b32 v158 offset:1904
    ds_write_addtid_b32 v159 offset:4080
    s_waitcnt lgkmcnt(15)
    v_mfma_f32_16x16x32_bf16 v[90:93], v[46:49], v[118:121], v[90:93]
    v_mfma_f32_16x16x32_bf16 v[90:93], v[50:53], v[122:125], v[90:93]
    v_mfma_f32_16x16x32_bf16 v[90:93], v[54:57], v[126:129], v[90:93]
    v_mfma_f32_16x16x32_bf16 v[90:93], v[58:61], v[130:133], v[90:93]
    ds_write_addtid_b32 v184 offset:4352
    ds_write_addtid_b32 v185 offset:6528
    ds_write_addtid_b32 v186 offset:4624
    ds_write_addtid_b32 v187 offset:6800
    ds_write_addtid_b32 v188 offset:4896
    ds_write_addtid_b32 v189 offset:7072
    ds_write_addtid_b32 v190 offset:5168
    ds_write_addtid_b32 v191 offset:7344
    ds_write_addtid_b32 v192 offset:5440
    ds_write_addtid_b32 v193 offset:7616
    ds_write_addtid_b32 v194 offset:5712
    ds_write_addtid_b32 v195 offset:7888
    ds_write_addtid_b32 v196 offset:5984
    ds_write_addtid_b32 v197 offset:8160
    ds_write_addtid_b32 v198 offset:6256
    ds_write_addtid_b32 v199 offset:8432
    ds_read_b128 v[94:97], v20 offset:0
    ds_read_b128 v[98:101], v20 offset:16
    ds_read_b128 v[102:105], v20 offset:32
    ds_read_b128 v[106:109], v20 offset:48
    ds_read_b128 v[224:227], v20 offset:4352
    ds_read_b128 v[228:231], v20 offset:4368
    ds_read_b128 v[232:235], v20 offset:4384
    ds_read_b128 v[236:239], v20 offset:4400
    s_cmp_eq_u32 s47, 0
    s_cbranch_scc1 X_noxp
    s_waitcnt vmcnt(0)
    v_cmp_ne_u64 vcc, v[4:5], s[62:63]
    s_cmp_eq_u32 vcc_lo, 0
    s_cbranch_scc1 X_xok
    s_mov_b32 s60, 0
    s_mov_b32 exec_lo, 0xffffffff
    s_mov_b32 exec_hi, 0x0
X_spx:
    buffer_load_dwordx2 v[4:5], v19, s[12:15], s51 offen sc1
    s_add_u32 s60, s60, 1
    s_cmp_gt_u32 s60, 400000
    s_cbranch_scc1 L_end
    s_waitcnt vmcnt(0)
    v_cmp_ne_u64 vcc, v[4:5], s[62:63]
    s_and_b64 exec, exec, vcc
    s_cbranch_scc1 X_spx
    s_mov_b64 exec, -1
X_xok:
    s_lshl_b32 s44, s38, 12
    s_mov_b32 m0, 17888
    s_add_u32 s44, s44, 6291456
    buffer_load_dwordx4 v1, s[12:15], s44 offen offset:0 sc1 lds
    buffer_load_dwordx4 v1, s[12:15], s44 offen offset:1024 sc1 lds
    buffer_load_dwordx4 v1, s[12:15], s44 offen offset:2048 sc1 lds
    buffer_load_dwordx4 v1, s[12:15], s44 offen offset:3072 sc1 lds
    s_mov_b32 m0, 48608
    s_add_u32 s44, s44, 4096
    buffer_load_dwordx4 v1, s[12:15], s44 offen offset:0 sc1 lds
    buffer_load_dwordx4 v1, s[12:15], s44 offen offset:1024 sc1 lds
    buffer_load_dwordx4 v1, s[12:15], s44 offen offset:2048 sc1 lds
    buffer_load_dwordx4 v1, s[12:15], s44 offen offset:3072 sc1 lds
    s_mov_b32 m0, s43
X_noxp:
    s_lshl_b32 s45, s37, 11
    s_add_u32 s45, s45, s42
    ds_write_addtid_b32 v160 offset:3536
    ds_write_addtid_b32 v161 offset:3264
    ds_write_addtid_b32 v162 offset:4080
    ds_write_addtid_b32 v163 offset:3808
    ds_write_addtid_b32 v164 offset:2448
    ds_write_addtid_b32 v165 offset:2176
    ds_write_addtid_b32 v166 offset:2992
    ds_write_addtid_b32 v167 offset:2720
    ds_write_addtid_b32 v200 offset:4352
    ds_write_addtid_b32 v201 offset:6528
    ds_write_addtid_b32 v202 offset:4624
    ds_write_addtid_b32 v203 offset:6800
    ds_write_addtid_b32 v204 offset:4896
    ds_write_addtid_b32 v205 offset:7072
    ds_write_addtid_b32 v206 offset:5168
    ds_write_addtid_b32 v207 offset:7344
    ds_write_addtid_b32 v208 offset:5440
    ds_write_addtid_b32 v209 offset:7616
    ds_write_addtid_b32 v210 offset:5712
    ds_write_addtid_b32 v211 offset:7888
    ds_write_addtid_b32 v212 offset:5984
    ds_write_addtid_b32 v213 offset:8160
    ds_write_addtid_b32 v214 offset:6256
    ds_write_addtid_b32 v215 offset:8432
    s_waitcnt lgkmcnt(15)
    v_mfma_f32_16x16x32_bf16 v[78:81], v[94:97], v[224:227], v[78:81]
    v_mfma_f32_16x16x32_bf16 v[78:81], v[98:101], v[228:231], v[78:81]
    v_mfma_f32_16x16x32_bf16 v[78:81], v[102:105], v[232:235], v[78:81]
    v_mfma_f32_16x16x32_bf16 v[78:81], v[106:109], v[236:239], v[78:81]
    ds_read_b128 v[46:49], v21 offset:0
    ds_read_b128 v[50:53], v21 offset:16
    ds_read_b128 v[54:57], v21 offset:32
    ds_read_b128 v[58:61], v21 offset:48
    ds_read_b128 v[118:121], v20 offset:4352
    ds_read_b128 v[122:125], v20 offset:4368
    ds_read_b128 v[126:129], v20 offset:4384
    ds_read_b128 v[130:133], v20 offset:4400
    ds_write_addtid_b32 v168 offset:1904
    ds_write_addtid_b32 v169 offset:1360
    ds_write_addtid_b32 v170 offset:816
    ds_write_addtid_b32 v171 offset:272
    ds_write_addtid_b32 v172 offset:2720
    ds_write_addtid_b32 v173 offset:2176
    ds_write_addtid_b32 v174 offset:3808
    ds_write_addtid_b32 v175 offset:3264
    ds_read_b128 v[94:97], v22 offset:0
    ds_read_b128 v[98:101], v22 offset:16
    ds_read_b128 v[102:105], v22 offset:32
    ds_read_b128 v[106:109], v22 offset:48
    ds_write_addtid_b32 v176 offset:2992
    ds_write_addtid_b32 v177 offset:4080
    ds_write_addtid_b32 v178 offset:1632
    ds_write_addtid_b32 v179 offset:544
    ds_write_addtid_b32 v180 offset:3264
    ds_write_addtid_b32 v181 offset:2176
    ds_write_addtid_b32 v182 offset:272
    ds_write_addtid_b32 v183 offset:1360
    s_waitcnt lgkmcnt(15)
    v_mfma_f32_16x16x32_bf16 v[82:85], v[46:49], v[118:121], v[82:85]
    v_mfma_f32_16x16x32_bf16 v[82:85], v[50:53], v[122:125], v[82:85]
    v_mfma_f32_16x16x32_bf16 v[82:85], v[54:57], v[126:129], v[82:85]
    v_mfma_f32_16x16x32_bf16 v[82:85], v[58:61], v[130:133], v[82:85]
    ds_write_addtid_b32 v216 offset:4352
    ds_write_addtid_b32 v217 offset:6528
    ds_write_addtid_b32 v218 offset:4624
    ds_write_addtid_b32 v219 offset:6800
    ds_write_addtid_b32 v220 offset:4896
    ds_write_addtid_b32 v221 offset:7072
    ds_write_addtid_b32 v222 offset:5168
    ds_write_addtid_b32 v223 offset:7344
    ds_write_addtid_b32 v33 offset:5440
    s_waitcnt lgkmcnt(15)
    v_mfma_f32_16x16x32_bf16 v[86:89], v[94:97], v[118:121], v[86:89]
    v_mfma_f32_16x16x32_bf16 v[86:89], v[98:101], v[122:125], v[86:89]
    v_mfma_f32_16x16x32_bf16 v[86:89], v[102:105], v[126:129], v[86:89]
    v_mfma_f32_16x16x32_bf16 v[86:89], v[106:109], v[130:133], v[86:89]
    ds_read_b128 v[46:49], v23 offset:0
    ds_read_b128 v[50:53], v23 offset:16
    ds_read_b128 v[54:57], v23 offset:32
    ds_read_b128 v[58:61], v23 offset:48
    ds_read_b128 v[224:227], v20 offset:4352
    ds_read_b128 v[228:231], v20 offset:4368
    ds_read_b128 v[232:235], v20 offset:4384
    ds_read_b128 v[236:239], v20 offset:4400
    s_waitcnt lgkmcnt(0)
    v_mfma_f32_16x16x32_bf16 v[90:93], v[46:49], v[224:227], v[90:93]
    v_mfma_f32_16x16x32_bf16 v[90:93], v[50:53], v[228:231], v[90:93]
    v_mfma_f32_16x16x32_bf16 v[90:93], v[54:57], v[232:235], v[90:93]
    v_mfma_f32_16x16x32_bf16 v[90:93], v[58:61], v[236:239], v[90:93]
    v_and_b32 v26, 15, v0
    v_mul_u32_u24 v26, 80, v26
    v_lshl_add_u32 v26, v29, 4, v26
    v_add_u32 v26, s50, v26
    s_mov_b32 exec_lo, 0xff00ff00
    s_mov_b32 exec_hi, 0xff00ff00
    v_mov_b32 v82, v86
    v_mov_b32 v83, v87
    v_mov_b32 v84, v88
    v_mov_b32 v85, v89
    s_mov_b64 exec, -1
    v_mov_b32 v27, 1
    ds_write_b128 v26, v[78:81] offset:22048
    ds_write_b128 v26, v[82:85] offset:23328
    s_mov_b32 exec_lo, 0x01ff01ff
    s_mov_b32 exec_hi, 0x01ff01ff
    ds_write_b128 v26, v[90:93] offset:24608
    s_mov_b64 exec, -1
    ds_write_b32 v25, v27 offset:16
    v_xor_b32 v25, 4, v25
    s_mul_i32 s41, s37, -6656
    s_add_u32 s41, s41, 3328
    v_add_u32 v30, s41, v26
    s_mov_b32 s60, 0
X_a1:
    ds_read_b32 v28, v25 offset:16
    s_add_u32 s60, s60, 1
    s_cmp_gt_u32 s60, 3200000
    s_cbranch_scc1 L_end
    s_waitcnt lgkmcnt(0)
    v_cmp_ne_u32 vcc, 1, v28
    s_cbranch_vccnz X_a1
    ds_read_b128 v[96:99], v30 offset:22048
    ds_read_b128 v[100:103], v30 offset:23328
    ds_read_b128 v[104:107], v30 offset:24608
    v_mov_b32 v46, 0
    v_mov_b32 v47, 0
    v_mov_b32 v48, 0
    v_mov_b32 v49, 0
    v_lshrrev_b32 v28, 2, v0
    v_mul_u32_u24 v28, 4096, v28
    v_add3_u32 v28, v28, v1, s42
    s_mov_b64 exec, 0xff
    ds_write_b128 v28, v[46:49] offset:4096
    s_mov_b64 exec, -1
    s_waitcnt lgkmcnt(1)
    v_add_f32 v78, v78, v96
    v_add_f32 v79, v79, v97
    v_add_f32 v80, v80, v98
    v_add_f32 v81, v81, v99
    v_add_f32 v82, v82, v100
    v_add_f32 v83, v83, v101
    v_add_f32 v84, v84, v102
    v_add_f32 v85, v85, v103
    v_add_f32 v90, v90, v104
    v_add_f32 v91, v91, v105
    v_add_f32 v92, v92, v106
    v_add_f32 v93, v93, v107
    ds_write_b128 v26, v[78:81] offset:8480
    ds_write_b128 v26, v[82:85] offset:9760
    s_mov_b32 exec_lo, 0x01ff01ff
    s_mov_b32 exec_hi, 0x01ff01ff
    ds_write_b128 v26, v[90:93] offset:11040
    s_mov_b64 exec, 3
    v_add_u32 v28, s50, v1
    ds_write_b128 v28, v[46:49] offset:8448
    s_mov_b64 exec, -1
    s_nop 0
    ds_read_b32 v96, v240 offset:8480
    ds_read_b32 v97, v241 offset:8480
    ds_read_b32 v98, v242 offset:8480
    ds_read_b32 v99, v243 offset:8480
    ds_read_b32 v100, v244 offset:8480
    ds_read_b32 v101, v245 offset:8480
    ds_read_b32 v102, v246 offset:8480
    ds_read_b32 v103, v247 offset:8480
    ds_read_b32 v104, v248 offset:8480
    ds_read_b32 v105, v249 offset:8480
    ds_read_b32 v106, v250 offset:8480
    ds_read_b32 v107, v251 offset:8480
    ds_read_b32 v108, v252 offset:8480
    ds_read_b32 v109, v253 offset:8480
    ds_read_b32 v110, v254 offset:8480
    ds_read_b32 v111, v255 offset:8480
    ds_read_b32 v112, v11 offset:8480
    v_lshl_add_u32 v26, v0, 5, s45
    v_add_u32 v20, 1024, v6
    v_add_u32 v21, 2048, v6
    v_add_u32 v22, 3072, v6
    s_waitcnt lgkmcnt(0)
    s_nop 0
    v_cvt_pk_bf16_f32 v136, v96, v97
    v_cvt_pk_bf16_f32 v137, v98, v99
    v_cvt_pk_bf16_f32 v138, v100, v101
    v_cvt_pk_bf16_f32 v139, v102, v103
    v_cvt_pk_bf16_f32 v140, v104, v105
    v_cvt_pk_bf16_f32 v141, v106, v107
    v_cvt_pk_bf16_f32 v142, v108, v109
    v_cvt_pk_bf16_f32 v143, v110, v111
    ds_write_b128 v26, v[136:139] offset:0
    ds_write_b128 v26, v[140:143] offset:16
    v_cvt_pk_bf16_f32 v144, v97, v98
    v_cvt_pk_bf16_f32 v145, v99, v100
    v_cvt_pk_bf16_f32 v146, v101, v102
    v_cvt_pk_bf16_f32 v147, v103, v104
    v_cvt_pk_bf16_f32 v148, v105, v106
    v_cvt_pk_bf16_f32 v149, v107, v108
    v_cvt_pk_bf16_f32 v150, v109, v110
    v_cvt_pk_bf16_f32 v151, v111, v112
    ds_write_b128 v26, v[144:147] offset:4160
    ds_write_b128 v26, v[148:151] offset:4176
    v_xor_b32 v26, 4, v25
    s_waitcnt vmcnt(0) lgkmcnt(0)
    ds_write_b32 v26, v27 offset:32
    s_mov_b32 s60, 0
X_a2:
    ds_read_b32 v28, v25 offset:32
    s_add_u32 s60, s60, 1
    s_cmp_gt_u32 s60, 3200000
    s_cbranch_scc1 L_end
    s_waitcnt lgkmcnt(0)
    v_cmp_ne_u32 vcc, 1, v28
    s_cbranch_vccnz X_a2
    s_mov_b32 s60, 0
X_a20:
    ds_read_b32 v28, v10 offset:61472
    s_add_u32 s60, s60, 1
    s_cmp_gt_u32 s60, 3200000
    s_cbranch_scc1 L_end
    s_waitcnt lgkmcnt(0)
    v_cmp_ne_u32 vcc, 1, v28
    s_cbranch_vccnz X_a20
    ds_read_b128 v[128:131], v7 offset:17408
    ds_read2_b32 v[96:97], v22 offset0:128 offset1:129
    ds_read2_b32 v[98:99], v22 offset0:130 offset1:131
    ds_read_b128 v[132:135], v7 offset:17920
    ds_read2_b32 v[100:101], v22 offset0:0 offset1:1
    ds_read2_b32 v[102:103], v22 offset0:2 offset1:3
    ds_read_b128 v[136:139], v7 offset:18432
    ds_read2_b32 v[104:105], v21 offset0:128 offset1:129
    ds_read2_b32 v[106:107], v21 offset0:130 offset1:131
    ds_read_b128 v[140:143], v7 offset:18944
    ds_read2_b32 v[108:109], v21 offset0:0 offset1:1
    ds_read2_b32 v[110:111], v21 offset0:2 offset1:3
    ds_read_b128 v[144:147], v7 offset:19456
    ds_read2_b32 v[112:113], v20 offset0:128 offset1:129
    ds_read2_b32 v[114:115], v20 offset0:130 offset1:131
    s_waitcnt lgkmcnt(12)
    v_mfma_f32_16x16x32_bf16 v[46:49], v[96:99], v[128:131], 0
    ds_read_b128 v[148:151], v7 offset:19968
    s_waitcnt lgkmcnt(10)
    v_mfma_f32_16x16x32_bf16 v[50:53], v[96:99], v[132:135], 0
    ds_read2_b32 v[116:117], v20 offset0:0 offset1:1
    v_mfma_f32_16x16x32_bf16 v[50:53], v[100:103], v[128:131], v[50:53]
    ds_read2_b32 v[118:119], v20 offset0:2 offset1:3
    v_mfma_f32_16x16x32_bf16 v[54:57], v[100:103], v[132:135], 0
    ds_read_b128 v[152:155], v7 offset:20480
    s_waitcnt lgkmcnt(10)
    v_mfma_f32_16x16x32_bf16 v[54:57], v[96:99], v[136:139], v[54:57]
    ds_read2_b32 v[120:121], v6 offset0:128 offset1:129
    v_mfma_f32_16x16x32_bf16 v[58:61], v[100:103], v[136:139], 0
    ds_read2_b32 v[122:123], v6 offset0:130 offset1:131
    v_mfma_f32_16x16x32_bf16 v[54:57], v[104:107], v[128:131], v[54:57]
    ds_read_b128 v[156:159], v7 offset:20992
    v_mfma_f32_16x16x32_bf16 v[58:61], v[104:107], v[132:135], v[58:61]
    ds_read2_b32 v[124:125], v6 offset0:0 offset1:1
    v_mfma_f32_16x16x32_bf16 v[62:65], v[104:107], v[136:139], 0
    ds_read2_b32 v[126:127], v6 offset0:2 offset1:3
    s_waitcnt lgkmcnt(12)
    v_mfma_f32_16x16x32_bf16 v[58:61], v[96:99], v[140:143], v[58:61]
    ds_read_b128 v[192:195], v7 offset:17472
    v_mfma_f32_16x16x32_bf16 v[62:65], v[100:103], v[140:143], v[62:65]
    ds_read2_b32 v[160:161], v22 offset0:144 offset1:145
    v_mfma_f32_16x16x32_bf16 v[66:69], v[104:107], v[140:143], 0
    ds_read2_b32 v[162:163], v22 offset0:146 offset1:147
    v_mfma_f32_16x16x32_bf16 v[58:61], v[108:111], v[128:131], v[58:61]
    ds_read_b128 v[196:199], v7 offset:17984
    v_mfma_f32_16x16x32_bf16 v[62:65], v[108:111], v[132:135], v[62:65]
    ds_read2_b32 v[164:165], v22 offset0:16 offset1:17
    v_mfma_f32_16x16x32_bf16 v[66:69], v[108:111], v[136:139], v[66:69]
    ds_read2_b32 v[166:167], v22 offset0:18 offset1:19
    v_mfma_f32_16x16x32_bf16 v[70:73], v[108:111], v[140:143], 0
    ds_read_b128 v[200:203], v7 offset:18496
    s_waitcnt lgkmcnt(15)
    v_mfma_f32_16x16x32_bf16 v[62:65], v[96:99], v[144:147], v[62:65]
    ds_read2_b32 v[168:169], v21 offset0:144 offset1:145
    v_mfma_f32_16x16x32_bf16 v[66:69], v[100:103], v[144:147], v[66:69]
    ds_read2_b32 v[170:171], v21 offset0:146 offset1:147
    v_mfma_f32_16x16x32_bf16 v[70:73], v[104:107], v[144:147], v[70:73]
    ds_read_b128 v[204:207], v7 offset:19008
    v_mfma_f32_16x16x32_bf16 v[74:77], v[108:111], v[144:147], 0
    ds_read2_b32 v[172:173], v21 offset0:16 offset1:17
    v_mfma_f32_16x16x32_bf16 v[62:65], v[112:115], v[128:131], v[62:65]
    ds_read2_b32 v[174:175], v21 offset0:18 offset1:19
    v_mfma_f32_16x16x32_bf16 v[66:69], v[112:115], v[132:135], v[66:69]
    ds_read_b128 v[208:211], v7 offset:19520
    v_mfma_f32_16x16x32_bf16 v[70:73], v[112:115], v[136:139], v[70:73]
    ds_read2_b32 v[176:177], v20 offset0:144 offset1:145
    v_mfma_f32_16x16x32_bf16 v[74:77], v[112:115], v[140:143], v[74:77]
    ds_read2_b32 v[178:179], v20 offset0:146 offset1:147
    s_waitcnt lgkmcnt(15)
    v_mfma_f32_16x16x32_bf16 v[66:69], v[96:99], v[148:151], v[66:69]
    ds_read_b128 v[212:215], v7 offset:20032
    v_mfma_f32_16x16x32_bf16 v[70:73], v[100:103], v[148:151], v[70:73]
    ds_read2_b32 v[180:181], v20 offset0:16 offset1:17
    v_mfma_f32_16x16x32_bf16 v[74:77], v[104:107], v[148:151], v[74:77]
    ds_read2_b32 v[182:183], v20 offset0:18 offset1:19
    v_mfma_f32_16x16x32_bf16 v[66:69], v[116:119], v[128:131], v[66:69]
    ds_read_b128 v[216:219], v7 offset:20544
    v_mfma_f32_16x16x32_bf16 v[70:73], v[116:119], v[132:135], v[70:73]
    ds_read2_b32 v[184:185], v6 offset0:144 offset1:145
    v_mfma_f32_16x16x32_bf16 v[74:77], v[116:119], v[136:139], v[74:77]
    ds_read2_b32 v[186:187], v6 offset0:146 offset1:147
    s_waitcnt lgkmcnt(15)
    v_mfma_f32_16x16x32_bf16 v[70:73], v[96:99], v[152:155], v[70:73]
    ds_read_b128 v[220:223], v7 offset:21056
    v_mfma_f32_16x16x32_bf16 v[74:77], v[100:103], v[152:155], v[74:77]
    ds_read2_b32 v[188:189], v6 offset0:16 offset1:17
    v_mfma_f32_16x16x32_bf16 v[70:73], v[120:123], v[128:131], v[70:73]
    ds_read2_b32 v[190:191], v6 offset0:18 offset1:19
    v_mfma_f32_16x16x32_bf16 v[74:77], v[120:123], v[132:135], v[74:77]
    s_waitcnt lgkmcnt(15)
    v_mfma_f32_16x16x32_bf16 v[74:77], v[96:99], v[156:159], v[74:77]
    v_mfma_f32_16x16x32_bf16 v[74:77], v[124:127], v[128:131], v[74:77]
    s_waitcnt lgkmcnt(0)
    v_mfma_f32_16x16x32_bf16 v[46:49], v[160:163], v[192:195], v[46:49]
    ds_read_b128 v[128:131], v7 offset:17536
    v_mfma_f32_16x16x32_bf16 v[50:53], v[160:163], v[196:199], v[50:53]
    ds_read2_b32 v[96:97], v22 offset0:160 offset1:161
    v_mfma_f32_16x16x32_bf16 v[50:53], v[164:167], v[192:195], v[50:53]
    ds_read2_b32 v[98:99], v22 offset0:162 offset1:163
    v_mfma_f32_16x16x32_bf16 v[54:57], v[164:167], v[196:199], v[54:57]
    ds_read_b128 v[132:135], v7 offset:18048
    v_mfma_f32_16x16x32_bf16 v[54:57], v[160:163], v[200:203], v[54:57]
    ds_read2_b32 v[100:101], v22 offset0:32 offset1:33
    v_mfma_f32_16x16x32_bf16 v[58:61], v[164:167], v[200:203], v[58:61]
    ds_read2_b32 v[102:103], v22 offset0:34 offset1:35
    v_mfma_f32_16x16x32_bf16 v[54:57], v[168:171], v[192:195], v[54:57]
    ds_read_b128 v[136:139], v7 offset:18560
    v_mfma_f32_16x16x32_bf16 v[58:61], v[168:171], v[196:199], v[58:61]
    ds_read2_b32 v[104:105], v21 offset0:160 offset1:161
    v_mfma_f32_16x16x32_bf16 v[62:65], v[168:171], v[200:203], v[62:65]
    ds_read2_b32 v[106:107], v21 offset0:162 offset1:163
    v_mfma_f32_16x16x32_bf16 v[58:61], v[160:163], v[204:207], v[58:61]
    ds_read_b128 v[140:143], v7 offset:19072
    v_mfma_f32_16x16x32_bf16 v[62:65], v[164:167], v[204:207], v[62:65]
    ds_read2_b32 v[108:109], v21 offset0:32 offset1:33
    v_mfma_f32_16x16x32_bf16 v[66:69], v[168:171], v[204:207], v[66:69]
    ds_read2_b32 v[110:111], v21 offset0:34 offset1:35
    v_mfma_f32_16x16x32_bf16 v[58:61], v[172:175], v[192:195], v[58:61]
    ds_read_b128 v[144:147], v7 offset:19584
    v_mfma_f32_16x16x32_bf16 v[62:65], v[172:175], v[196:199], v[62:65]
    ds_read2_b32 v[112:113], v20 offset0:160 offset1:161
    v_mfma_f32_16x16x32_bf16 v[66:69], v[172:175], v[200:203], v[66:69]
    ds_read2_b32 v[114:115], v20 offset0:162 offset1:163
    v_mfma_f32_16x16x32_bf16 v[70:73], v[172:175], v[204:207], v[70:73]
    ds_read_b128 v[148:151], v7 offset:20096
    v_mfma_f32_16x16x32_bf16 v[62:65], v[160:163], v[208:211], v[62:65]
    ds_read2_b32 v[116:117], v20 offset0:32 offset1:33
    v_mfma_f32_16x16x32_bf16 v[66:69], v[164:167], v[208:211], v[66:69]
    ds_read2_b32 v[118:119], v20 offset0:34 offset1:35
    v_mfma_f32_16x16x32_bf16 v[70:73], v[168:171], v[208:211], v[70:73]
    ds_read_b128 v[152:155], v7 offset:20608
    v_mfma_f32_16x16x32_bf16 v[74:77], v[172:175], v[208:211], v[74:77]
    ds_read2_b32 v[120:121], v6 offset0:160 offset1:161
    v_mfma_f32_16x16x32_bf16 v[62:65], v[176:179], v[192:195], v[62:65]
    ds_read2_b32 v[122:123], v6 offset0:162 offset1:163
    v_mfma_f32_16x16x32_bf16 v[66:69], v[176:179], v[196:199], v[66:69]
    ds_read_b128 v[156:159], v7 offset:21120
    v_mfma_f32_16x16x32_bf16 v[70:73], v[176:179], v[200:203], v[70:73]
    ds_read2_b32 v[124:125], v6 offset0:32 offset1:33
    v_mfma_f32_16x16x32_bf16 v[74:77], v[176:179], v[204:207], v[74:77]
    ds_read2_b32 v[126:127], v6 offset0:34 offset1:35
    v_mfma_f32_16x16x32_bf16 v[66:69], v[160:163], v[212:215], v[66:69]
    v_mfma_f32_16x16x32_bf16 v[70:73], v[164:167], v[212:215], v[70:73]
    v_mfma_f32_16x16x32_bf16 v[74:77], v[168:171], v[212:215], v[74:77]
    v_mfma_f32_16x16x32_bf16 v[66:69], v[180:183], v[192:195], v[66:69]
    v_mfma_f32_16x16x32_bf16 v[70:73], v[180:183], v[196:199], v[70:73]
    v_mfma_f32_16x16x32_bf16 v[74:77], v[180:183], v[200:203], v[74:77]
    v_mfma_f32_16x16x32_bf16 v[70:73], v[160:163], v[216:219], v[70:73]
    v_mfma_f32_16x16x32_bf16 v[74:77], v[164:167], v[216:219], v[74:77]
    v_mfma_f32_16x16x32_bf16 v[70:73], v[184:187], v[192:195], v[70:73]
    v_mfma_f32_16x16x32_bf16 v[74:77], v[184:187], v[196:199], v[74:77]
    v_mfma_f32_16x16x32_bf16 v[74:77], v[160:163], v[220:223], v[74:77]
    v_mfma_f32_16x16x32_bf16 v[74:77], v[188:191], v[192:195], v[74:77]
    s_waitcnt lgkmcnt(0)
    v_mfma_f32_16x16x32_bf16 v[46:49], v[96:99], v[128:131], v[46:49]
    ds_read_b128 v[192:195], v7 offset:17600
    v_mfma_f32_16x16x32_bf16 v[50:53], v[96:99], v[132:135], v[50:53]
    ds_read2_b32 v[160:161], v22 offset0:176 offset1:177
    v_mfma_f32_16x16x32_bf16 v[50:53], v[100:103], v[128:131], v[50:53]
    ds_read2_b32 v[162:163], v22 offset0:178 offset1:179
    v_mfma_f32_16x16x32_bf16 v[54:57], v[100:103], v[132:135], v[54:57]
    ds_read_b128 v[196:199], v7 offset:18112
    v_mfma_f32_16x16x32_bf16 v[54:57], v[96:99], v[136:139], v[54:57]
    ds_read2_b32 v[164:165], v22 offset0:48 offset1:49
    v_mfma_f32_16x16x32_bf16 v[58:61], v[100:103], v[136:139], v[58:61]
    ds_read2_b32 v[166:167], v22 offset0:50 offset1:51
    v_mfma_f32_16x16x32_bf16 v[54:57], v[104:107], v[128:131], v[54:57]
    ds_read_b128 v[200:203], v7 offset:18624
    v_mfma_f32_16x16x32_bf16 v[58:61], v[104:107], v[132:135], v[58:61]
    ds_read2_b32 v[168:169], v21 offset0:176 offset1:177
    v_mfma_f32_16x16x32_bf16 v[62:65], v[104:107], v[136:139], v[62:65]
    ds_read2_b32 v[170:171], v21 offset0:178 offset1:179
    v_mfma_f32_16x16x32_bf16 v[58:61], v[96:99], v[140:143], v[58:61]
    ds_read_b128 v[204:207], v7 offset:19136
    v_mfma_f32_16x16x32_bf16 v[62:65], v[100:103], v[140:143], v[62:65]
    ds_read2_b32 v[172:173], v21 offset0:48 offset1:49
    v_mfma_f32_16x16x32_bf16 v[66:69], v[104:107], v[140:143], v[66:69]
    ds_read2_b32 v[174:175], v21 offset0:50 offset1:51
    v_mfma_f32_16x16x32_bf16 v[58:61], v[108:111], v[128:131], v[58:61]
    ds_read_b128 v[208:211], v7 offset:19648
    v_mfma_f32_16x16x32_bf16 v[62:65], v[108:111], v[132:135], v[62:65]
    ds_read2_b32 v[176:177], v20 offset0:176 offset1:177
    v_mfma_f32_16x16x32_bf16 v[66:69], v[108:111], v[136:139], v[66:69]
    ds_read2_b32 v[178:179], v20 offset0:178 offset1:179
    v_mfma_f32_16x16x32_bf16 v[70:73], v[108:111], v[140:143], v[70:73]
    ds_read_b128 v[212:215], v7 offset:20160
    v_mfma_f32_16x16x32_bf16 v[62:65], v[96:99], v[144:147], v[62:65]
    ds_read2_b32 v[180:181], v20 offset0:48 offset1:49
    v_mfma_f32_16x16x32_bf16 v[66:69], v[100:103], v[144:147], v[66:69]
    ds_read2_b32 v[182:183], v20 offset0:50 offset1:51
    v_mfma_f32_16x16x32_bf16 v[70:73], v[104:107], v[144:147], v[70:73]
    ds_read_b128 v[216:219], v7 offset:20672
    v_mfma_f32_16x16x32_bf16 v[74:77], v[108:111], v[144:147], v[74:77]
    ds_read2_b32 v[184:185], v6 offset0:176 offset1:177
    v_mfma_f32_16x16x32_bf16 v[62:65], v[112:115], v[128:131], v[62:65]
    ds_read2_b32 v[186:187], v6 offset0:178 offset1:179
    v_mfma_f32_16x16x32_bf16 v[66:69], v[112:115], v[132:135], v[66:69]
    ds_read_b128 v[220:223], v7 offset:21184
    v_mfma_f32_16x16x32_bf16 v[70:73], v[112:115], v[136:139], v[70:73]
    ds_read2_b32 v[188:189], v6 offset0:48 offset1:49
    v_mfma_f32_16x16x32_bf16 v[74:77], v[112:115], v[140:143], v[74:77]
    ds_read2_b32 v[190:191], v6 offset0:50 offset1:51
    v_mfma_f32_16x16x32_bf16 v[66:69], v[96:99], v[148:151], v[66:69]
    v_mfma_f32_16x16x32_bf16 v[70:73], v[100:103], v[148:151], v[70:73]
    v_mfma_f32_16x16x32_bf16 v[74:77], v[104:107], v[148:151], v[74:77]
    v_mfma_f32_16x16x32_bf16 v[66:69], v[116:119], v[128:131], v[66:69]
    v_mfma_f32_16x16x32_bf16 v[70:73], v[116:119], v[132:135], v[70:73]
    v_mfma_f32_16x16x32_bf16 v[74:77], v[116:119], v[136:139], v[74:77]
    v_mfma_f32_16x16x32_bf16 v[70:73], v[96:99], v[152:155], v[70:73]
    v_mfma_f32_16x16x32_bf16 v[74:77], v[100:103], v[152:155], v[74:77]
    v_mfma_f32_16x16x32_bf16 v[70:73], v[120:123], v[128:131], v[70:73]
    v_mfma_f32_16x16x32_bf16 v[74:77], v[120:123], v[132:135], v[74:77]
    v_mfma_f32_16x16x32_bf16 v[74:77], v[96:99], v[156:159], v[74:77]
    v_mfma_f32_16x16x32_bf16 v[74:77], v[124:127], v[128:131], v[74:77]
    s_waitcnt lgkmcnt(0)
    v_mfma_f32_16x16x32_bf16 v[46:49], v[160:163], v[192:195], v[46:49]
    v_mfma_f32_16x16x32_bf16 v[50:53], v[160:163], v[196:199], v[50:53]
    v_mfma_f32_16x16x32_bf16 v[50:53], v[164:167], v[192:195], v[50:53]
    v_mfma_f32_16x16x32_bf16 v[54:57], v[164:167], v[196:199], v[54:57]
    v_mfma_f32_16x16x32_bf16 v[54:57], v[160:163], v[200:203], v[54:57]
    v_mfma_f32_16x16x32_bf16 v[58:61], v[164:167], v[200:203], v[58:61]
    v_mfma_f32_16x16x32_bf16 v[54:57], v[168:171], v[192:195], v[54:57]
    v_mfma_f32_16x16x32_bf16 v[58:61], v[168:171], v[196:199], v[58:61]
    v_mfma_f32_16x16x32_bf16 v[62:65], v[168:171], v[200:203], v[62:65]
    v_mfma_f32_16x16x32_bf16 v[58:61], v[160:163], v[204:207], v[58:61]
    v_mfma_f32_16x16x32_bf16 v[62:65], v[164:167], v[204:207], v[62:65]
    v_mfma_f32_16x16x32_bf16 v[66:69], v[168:171], v[204:207], v[66:69]
    v_mfma_f32_16x16x32_bf16 v[58:61], v[172:175], v[192:195], v[58:61]
    v_mfma_f32_16x16x32_bf16 v[62:65], v[172:175], v[196:199], v[62:65]
    v_mfma_f32_16x16x32_bf16 v[66:69], v[172:175], v[200:203], v[66:69]
    v_mfma_f32_16x16x32_bf16 v[70:73], v[172:175], v[204:207], v[70:73]
    v_mfma_f32_16x16x32_bf16 v[62:65], v[160:163], v[208:211], v[62:65]
    v_mfma_f32_16x16x32_bf16 v[66:69], v[164:167], v[208:211], v[66:69]
    v_mfma_f32_16x16x32_bf16 v[70:73], v[168:171], v[208:211], v[70:73]
    v_mfma_f32_16x16x32_bf16 v[74:77], v[172:175], v[208:211], v[74:77]
    v_mfma_f32_16x16x32_bf16 v[62:65], v[176:179], v[192:195], v[62:65]
    v_mfma_f32_16x16x32_bf16 v[66:69], v[176:179], v[196:199], v[66:69]
    v_mfma_f32_16x16x32_bf16 v[70:73], v[176:179], v[200:203], v[70:73]
    v_mfma_f32_16x16x32_bf16 v[74:77], v[176:179], v[204:207], v[74:77]
    v_mfma_f32_16x16x32_bf16 v[66:69], v[160:163], v[212:215], v[66:69]
    v_mfma_f32_16x16x32_bf16 v[70:73], v[164:167], v[212:215], v[70:73]
    v_mfma_f32_16x16x32_bf16 v[74:77], v[168:171], v[212:215], v[74:77]
    v_mfma_f32_16x16x32_bf16 v[66:69], v[180:183], v[192:195], v[66:69]
    v_mfma_f32_16x16x32_bf16 v[70:73], v[180:183], v[196:199], v[70:73]
    v_mfma_f32_16x16x32_bf16 v[74:77], v[180:183], v[200:203], v[74:77]
    v_mfma_f32_16x16x32_bf16 v[70:73], v[160:163], v[216:219], v[70:73]
    v_mfma_f32_16x16x32_bf16 v[74:77], v[164:167], v[216:219], v[74:77]
    v_mfma_f32_16x16x32_bf16 v[70:73], v[184:187], v[192:195], v[70:73]
    v_mfma_f32_16x16x32_bf16 v[74:77], v[184:187], v[196:199], v[74:77]
    v_mfma_f32_16x16x32_bf16 v[74:77], v[160:163], v[220:223], v[74:77]
    v_mfma_f32_16x16x32_bf16 v[74:77], v[188:191], v[192:195], v[74:77]
    s_setprio 3
    s_add_u32 s42, s42, 22016
    s_lshl_b32 s41, s37, 12
    s_add_u32 s44, s41, s42
    v_add_u32 v30, s44, v1
    s_xor_b32 s41, s41, 4096
    s_add_u32 s44, s41, s42
    v_add_u32 v29, s44, v1
    s_cmp_eq_u32 s37, 0
    s_cbranch_scc1 X_noswap
    ds_write_b128 v30, v[46:49] offset:0
    ds_write_b128 v30, v[50:53] offset:1024
    ds_write_b128 v30, v[54:57] offset:2048
    ds_write_b128 v30, v[58:61] offset:3072
    s_branch X_sent
X_noswap:
    ds_write_b128 v30, v[62:65] offset:0
    ds_write_b128 v30, v[66:69] offset:1024
    ds_write_b128 v30, v[70:73] offset:2048
    ds_write_b128 v30, v[74:77] offset:3072
X_sent:
    ds_write_b32 v26, v27 offset:64
    s_mov_b32 s60, 0
X_a4:
    ds_read_b32 v28, v25 offset:64
    s_add_u32 s60, s60, 1
    s_cmp_gt_u32 s60, 3200000
    s_cbranch_scc1 L_end
    s_waitcnt lgkmcnt(0)
    v_cmp_ne_u32 vcc, 1, v28
    s_cbranch_vccnz X_a4
    s_cmp_eq_u32 s37, 0
    s_cbranch_scc1 X_r1
    ds_read_b128 v[46:49], v29 offset:0
    ds_read_b128 v[50:53], v29 offset:1024
    ds_read_b128 v[54:57], v29 offset:2048
    ds_read_b128 v[58:61], v29 offset:3072
    s_branch X_r2
X_r1:
    ds_read_b128 v[62:65], v29 offset:0
    ds_read_b128 v[66:69], v29 offset:1024
    ds_read_b128 v[70:73], v29 offset:2048
    ds_read_b128 v[74:77], v29 offset:3072
X_r2:
    v_and_b32 v26, 15, v0
    v_lshl_add_u32 v26, v26, 5, s44
    v_lshrrev_b32 v30, 4, v0
    v_lshl_add_u32 v26, v30, 3, v26
    s_lshl_b32 s41, s38, 12
    s_lshl_b32 s44, s37, 11
    s_add_u32 s41, s41, s44
    s_add_u32 s41, s41, 9437184
    s_waitcnt lgkmcnt(0)
    v_add_f32 v46, v46, v62
    v_add_f32 v47, v47, v63
    v_add_f32 v48, v48, v64
    v_add_f32 v49, v49, v65
    v_add_f32 v50, v50, v66
    v_add_f32 v51, v51, v67
    v_add_f32 v52, v52, v68
    v_add_f32 v53, v53, v69
    v_add_f32 v54, v54, v70
    v_add_f32 v55, v55, v71
    v_add_f32 v56, v56, v72
    v_add_f32 v57, v57, v73
    v_add_f32 v58, v58, v74
    v_add_f32 v59, v59, v75
    v_add_f32 v60, v60, v76
    v_add_f32_e64 v61, v61, v77
    v_cvt_pk_bf16_f32 v46, v46, v47
    v_cvt_pk_bf16_f32 v47, v48, v49
    v_cvt_pk_bf16_f32 v48, v50, v51
    v_cvt_pk_bf16_f32 v49, v52, v53
    v_cvt_pk_bf16_f32 v50, v54, v55
    v_cvt_pk_bf16_f32 v51, v56, v57
    v_cvt_pk_bf16_f32 v52, v58, v59
    v_cvt_pk_bf16_f32 v53, v60, v61
    ds_write_b64 v26, v[46:47] offset:0
    ds_write_b64 v26, v[48:49] offset:512
    ds_write_b64 v26, v[50:51] offset:1024
    ds_write_b64 v26, v[52:53] offset:1536
    ds_read_b128 v[62:65], v29 offset:0
    ds_read_b128 v[66:69], v29 offset:1024
    s_waitcnt lgkmcnt(0)
    s_mov_b32 s60, 0
    s_branch X_s_1
X_s:
    s_sleep 2
X_s_1:
    ds_read_b32 v28, v10 offset:61452
    s_add_u32 s60, s60, 1
    s_cmp_gt_u32 s60, 3200000
    s_cbranch_scc1 L_end
    s_waitcnt lgkmcnt(0)
    v_cmp_ne_u32 vcc, 4, v28
    s_cbranch_vccnz X_s
    buffer_store_dwordx4 v[62:65], v1, s[12:15], s41 offen offset:0 sc1
    buffer_store_dwordx4 v[66:69], v1, s[12:15], s41 offen offset:1024 sc1
    s_mov_b32 s60, 0
X_role:
    ds_read_b32 v28, v10 offset:61448
    s_add_u32 s60, s60, 1
    s_cmp_gt_u32 s60, 3200000
    s_cbranch_scc1 L_end
    s_waitcnt lgkmcnt(0)
    v_readfirstlane_b32 s69, v28
    s_cmp_eq_u32 s69, 0
    s_cbranch_scc1 X_role
    s_sub_u32 s69, s69, 1
    s_bfe_u32 s39, s69, 0x30002
    v_lshrrev_b32 v24, 2, v0
    v_and_b32 v28, 3, v0
    v_mul_u32_u24 v24, 896, v24
    v_lshl_add_u32 v24, v28, 4, v24
    s_mul_i32 s16, s3, 100352
    s_lshl_b32 s17, s39, 7
    s_add_u32 s16, s16, s17
    s_mul_i32 s17, s3, 7168
    s_add_u32 s17, s17, 65536
    s_add_u32 s18, s17, 7168
    s_cmp_eq_u32 s39, 7
    s_cselect_b32 s18, 0, s18
    s_waitcnt vmcnt(0)
    s_mov_b64 exec, 1
    ds_add_rtn_u32 v27, v10, v27 offset:61444
    s_mov_b64 exec, -1
    s_add_u32 s41, s61, 13893632
    s_waitcnt lgkmcnt(0)
    v_readfirstlane_b32 s44, v27
    s_cmp_lg_u32 s44, 3
    s_cbranch_scc1 X_tail_wo
    v_lshlrev_b32 v27, 15, v0
    s_mov_b64 exec, 0xff
    buffer_store_dwordx2 v[8:9], v27, s[12:15], s41 offen sc1
    s_mov_b64 exec, -1
X_tail_wo:
    s_getpc_b64 s[66:67]
X_pc3:
    s_sub_u32 s66, s66, X_pc3-L_last
    s_subb_u32 s67, s67, 0
    s_lshl_b32 s41, s3, 10
    v_lshl_add_u32 v4, v0, 7, s41
    s_mov_b64 exec, 0xff
    global_load_dword v5, v4, s[66:67]
    s_mov_b64 exec, -1
    s_cmp_eq_u32 s39, 7
    s_cbranch_scc1 L_end
X_wo:
    s_mov_b32 m0, s17
    s_nop 0
    buffer_load_dwordx4 v24, s[52:55], s16 offen lds
    s_add_u32 m0, s17, 28608
    s_add_u32 s17, s17, 1024
    buffer_load_dwordx4 v24, s[52:55], s16 offen offset:64 lds
    s_add_u32 s16, s16, 14336
    s_waitcnt vmcnt(1)
    s_cmp_lt_u32 s17, s18
    s_cbranch_scc1 X_wo
    s_mov_b32 s60, 0
    s_branch X_y4_1
X_y4:
    s_sleep 4
X_y4_1:
    ds_read_b32 v28, v10 offset:61444
    s_add_u32 s60, s60, 1
    s_cmp_gt_u32 s60, 3200000
    s_cbranch_scc1 L_end
    s_waitcnt lgkmcnt(0)
    v_cmp_ne_u32 vcc, 4, v28
    s_cbranch_vccnz X_y4
    s_lshr_b32 s36, s3, 1
    s_lshl1_add_u32 s36, s39, s36
    s_and_b32 s44, s69, 3
    s_lshl2_add_u32 s44, s68, s44
    s_lshl_b32 s41, s36, 11
    v_lshl_add_u32 v26, v0, 7, s41
    s_lshl_b32 s41, s44, 7
    s_add_u32 s41, s41, 28672
    s_mov_b64 exec, 0x10000
    v_mov_b32 v26, s41
    s_lshl_b32 s41, s68, 15
    s_add_u32 s41, s41, 13893632
    s_mov_b32 s60, 0
    s_mov_b32 exec_lo, 0x1ffff
    s_mov_b32 exec_hi, 0x0
    s_branch X_spy_1
X_spy:
    s_sleep 16
X_spy_1:
    buffer_load_dwordx2 v[28:29], v26, s[12:15], s41 offen sc1
    s_add_u32 s60, s60, 1
    s_cmp_gt_u32 s60, 400000
    s_cbranch_scc1 L_end
    s_waitcnt vmcnt(0)
    v_cmp_ne_u64 vcc, v[28:29], s[62:63]
    s_and_b64 exec, exec, vcc
    s_cbranch_scc1 X_spy
    s_mov_b64 exec, -1
    v_lshrrev_b32 v26, 2, v0
    v_and_b32 v27, 3, v0
    v_lshlrev_b32 v27, 4, v27
    v_lshl_add_u32 v26, v26, 12, v27
    s_and_b32 s45, s3, 1
    s_lshl1_add_u32 s45, s44, s45
    s_lshl_b32 s45, s45, 6
    s_lshl_b32 s41, s36, 17
    s_add_u32 s41, s41, s45
    s_add_u32 s41, s41, 9437184
    s_mul_i32 s45, s3, 2304
    s_add_u32 m0, s45, 49152
    s_add_u32 s45, s41, 64512
    buffer_load_dwordx4 v26, s[12:15], s41 offen sc1 lds
    buffer_load_dwordx4 v26, s[12:15], s45 offen offset:1024 sc1 lds
    v_lshlrev_b32 v26, 2, v0
    s_lshl_b32 s41, s44, 8
    s_add_u32 s41, s41, 8386560
    buffer_load_dword v26, s[12:15], s41 offen offset:2048 sc1 lds
    s_getpc_b64 s[66:67]
X_pc2:
    s_sub_u32 s66, s66, X_pc2-L_tail
    s_subb_u32 s67, s67, 0
    s_lshl_b32 s41, s3, 10
    v_lshl_add_u32 v26, v0, 7, s41
    s_mov_b64 exec, 0xff
    global_load_dword v5, v26, s[66:67]
    s_waitcnt vmcnt(0)
    s_endpgm
L_gate:
    s_lshl_b32 s36, s35, 6
    v_lshrrev_b32 v12, 3, v0
    v_add_u32 v12, s36, v12
    v_mul_u32_u24 v4, 896, v12
    v_lshrrev_b32 v13, 4, v0
    v_xor_b32 v14, v13, v0
    v_and_b32 v14, 7, v14
    v_lshl_add_u32 v5, v14, 4, v4
    v_xor_b32 v14, 4, v14
    v_lshl_add_u32 v6, v14, 4, v4
    v_add_u32 v6, 6144, v6
    s_lshl_b32 s37, s3, 14
    s_mov_b32 m0, s37
    s_lshl_b32 s38, s3, 7
    v_mov_b32 v11, 61440
    v_mov_b32 v10, 0
    v_mov_b32 v9, 4
    ds_write2_b32 v11, v9, v10 offset0:1 offset1:2
    ds_write_b32 v11, v10 offset:12
    s_waitcnt lgkmcnt(0)
    s_cmp_eq_u32 s3, 7
    s_cbranch_scc1 T_w7
    buffer_load_dwordx4 v5, s[4:7], s38 offen lds
    buffer_load_dwordx4 v6, s[4:7], s38 offen offset:1024 lds
    s_add_u32 m0, m0, 2048
    s_add_u32 s38, s38, 14336
    buffer_load_dwordx4 v5, s[4:7], s38 offen lds
    buffer_load_dwordx4 v6, s[4:7], s38 offen offset:1024 lds
    s_add_u32 m0, m0, 2048
    s_add_u32 s38, s38, 14336
    buffer_load_dwordx4 v5, s[4:7], s38 offen lds
    buffer_load_dwordx4 v6, s[4:7], s38 offen offset:1024 lds
    s_add_u32 m0, m0, 2048
    s_add_u32 s38, s38, 14336
    buffer_load_dwordx4 v5, s[4:7], s38 offen lds
    buffer_load_dwordx4 v6, s[4:7], s38 offen offset:1024 lds
    v_bfe_u32 v14, v0, 2, 2
    v_lshl_add_u32 v14, v13, 4, v14
    v_lshl_add_u32 v14, v14, 7, s37
    v_lshrrev_b32 v15, 2, v0
    v_xor_b32 v15, v15, v0
    v_and_b32 v15, 2, v15
    v_lshl_add_u32 v14, v15, 3, v14
    v_and_b32 v15, 1, v0
    v_lshl_add_u32 v16, v15, 3, v14
    v_xor_b32 v17, 32, v16
    v_xor_b32 v18, 64, v16
    v_xor_b32 v19, 96, v16
    v_and_b32 v14, 15, v0
    v_mul_u32_u24 v14, 144, v14
    v_lshl_add_u32 v14, v13, 5, v14
    v_add_u32 v20, s37, v14
    v_lshrrev_b32 v14, 3, v0
    v_and_b32 v15, 7, v0
    v_lshlrev_b32 v15, 4, v15
    v_lshl_add_u32 v22, v14, 12, v15
    v_mul_u32_u24 v14, 144, v14
    v_add3_u32 v21, v14, v15, s37
    s_lshl_b32 s38, s3, 18
    s_lshl_b32 s39, s35, 7
    s_add_u32 s38, s38, s39
    s_add_u32 s38, s38, 6291456
    s_waitcnt vmcnt(0)
    ds_read_b64_tr_b16 v[80:81], v16 offset:0
    ds_read_b64_tr_b16 v[82:83], v17 offset:512
    ds_read_b64_tr_b16 v[84:85], v18 offset:1024
    ds_read_b64_tr_b16 v[86:87], v19 offset:1536
    ds_read_b64_tr_b16 v[88:89], v17 offset:0
    ds_read_b64_tr_b16 v[90:91], v16 offset:512
    ds_read_b64_tr_b16 v[92:93], v19 offset:1024
    ds_read_b64_tr_b16 v[94:95], v18 offset:1536
    ds_read_b64_tr_b16 v[96:97], v18 offset:0
    ds_read_b64_tr_b16 v[98:99], v19 offset:512
    ds_read_b64_tr_b16 v[100:101], v16 offset:1024
    ds_read_b64_tr_b16 v[102:103], v17 offset:1536
    ds_read_b64_tr_b16 v[104:105], v19 offset:0
    ds_read_b64_tr_b16 v[106:107], v18 offset:512
    ds_read_b64_tr_b16 v[108:109], v17 offset:1024
    ds_read_b64_tr_b16 v[110:111], v16 offset:1536
    s_waitcnt lgkmcnt(0)
    ds_write_b128 v20, v[80:83] offset:0
    ds_write_b128 v20, v[84:87] offset:16
    ds_read_b128 v[80:83], v21 offset:0
    ds_read_b128 v[84:87], v21 offset:1152
    ds_write_b128 v20, v[88:91] offset:2304
    ds_write_b128 v20, v[92:95] offset:2320
    ds_read_b128 v[88:91], v21 offset:2304
    ds_read_b128 v[92:95], v21 offset:3456
    s_waitcnt lgkmcnt(4)
    buffer_store_dwordx4 v[80:83], v22, s[12:15], s38 offen sc1
    s_add_u32 s38, s38, 32768
    buffer_store_dwordx4 v[84:87], v22, s[12:15], s38 offen sc1
    s_add_u32 s38, s38, 32768
    ds_write_b128 v20, v[96:99] offset:4608
    ds_write_b128 v20, v[100:103] offset:4624
    ds_read_b128 v[96:99], v21 offset:4608
    ds_read_b128 v[100:103], v21 offset:5760
    s_waitcnt lgkmcnt(4)
    buffer_store_dwordx4 v[88:91], v22, s[12:15], s38 offen sc1
    s_add_u32 s38, s38, 32768
    buffer_store_dwordx4 v[92:95], v22, s[12:15], s38 offen sc1
    s_add_u32 s38, s38, 32768
    ds_write_b128 v20, v[104:107] offset:6912
    ds_write_b128 v20, v[108:111] offset:6928
    ds_read_b128 v[104:107], v21 offset:6912
    ds_read_b128 v[108:111], v21 offset:8064
    s_waitcnt lgkmcnt(4)
    buffer_store_dwordx4 v[96:99], v22, s[12:15], s38 offen sc1
    s_add_u32 s38, s38, 32768
    buffer_store_dwordx4 v[100:103], v22, s[12:15], s38 offen sc1
    s_add_u32 s38, s38, 32768
    s_waitcnt lgkmcnt(0)
    buffer_store_dwordx4 v[104:107], v22, s[12:15], s38 offen sc1
    s_add_u32 s38, s38, 32768
    buffer_store_dwordx4 v[108:111], v22, s[12:15], s38 offen sc1
    s_add_u32 s38, s38, 32768
    s_branch T_st
T_w7:
    v_add_u32 v20, 0, v0
    v_min_u32 v20, 97, v20
    v_mul_u32_u24 v21, 9363, v20
    v_lshrrev_b32 v21, 16, v21
    v_mul_u32_u24 v21, 1792, v21
    v_lshl_add_u32 v20, v20, 7, v21
    s_mul_i32 s38, s35, 37632
    buffer_load_dword v22, v20, s[8:11], s38 offen
    v_add_u32 v20, 64, v0
    v_min_u32 v20, 97, v20
    v_mul_u32_u24 v21, 9363, v20
    v_lshrrev_b32 v21, 16, v21
    v_mul_u32_u24 v21, 1792, v21
    v_lshl_add_u32 v20, v20, 7, v21
    s_mul_i32 s38, s35, 37632
    buffer_load_dword v22, v20, s[8:11], s38 offen
    s_lshl_b32 s41, s68, 4
    s_add_u32 s41, s41, 128
    s_mov_b32 s33, 1
    s_atomic_add s33, s[48:49], s41 glc
T_st:
    global_load_dwordx2 v[8:9], v10, s[48:49] sc1
    s_waitcnt vmcnt(0)
    s_mov_b32 s60, 0
T_tok:
    v_readfirstlane_b32 s62, v8
    v_readfirstlane_b32 s63, v9
    s_cmp_lg_u64 s[62:63], 0
    s_cbranch_scc1 T_tok_ok
    global_load_dwordx2 v[8:9], v10, s[48:49] sc1
    s_add_u32 s60, s60, 1
    s_cmp_gt_u32 s60, 400000
    s_cbranch_scc1 L_end
    s_waitcnt vmcnt(0)
    s_branch T_tok
T_tok_ok:
    s_add_u32 s39, s61, 13631488
    s_barrier
    s_cmp_lg_u32 s3, 0
    s_cbranch_scc1 T_np
    v_lshlrev_b32 v14, 15, v0
    s_mov_b64 exec, 0xff
    buffer_store_dwordx2 v[8:9], v14, s[12:15], s39 offen sc1
    s_mov_b64 exec, -1
T_np:
    s_barrier
    s_cmp_lg_u32 s3, 7
    s_cbranch_scc1 T_g
    s_waitcnt lgkmcnt(0)
    s_and_b32 s41, s33, 31
    s_lshl_b32 s69, s68, 5
    s_add_u32 s41, s41, s69
    s_add_u32 s41, s41, 1
    v_mov_b32 v14, s41
    ds_write_b32 v10, v14 offset:61448
T_g:
    v_and_b32 v14, 7, v0
    v_lshlrev_b32 v14, 4, v14
    s_mul_i32 s38, s3, 7168
    v_add3_u32 v15, v4, v14, s38
    global_load_dwordx4 v[24:27], v15, s[4:5] offset:0
    global_load_dwordx4 v[52:55], v14, s[28:29] offset:0
    global_load_dwordx4 v[28:31], v15, s[4:5] offset:128
    global_load_dwordx4 v[56:59], v14, s[28:29] offset:128
    global_load_dwordx4 v[32:35], v15, s[4:5] offset:256
    global_load_dwordx4 v[60:63], v14, s[28:29] offset:256
    global_load_dwordx4 v[36:39], v15, s[4:5] offset:384
    global_load_dwordx4 v[64:67], v14, s[28:29] offset:384
    global_load_dwordx4 v[40:43], v15, s[4:5] offset:512
    global_load_dwordx4 v[68:71], v14, s[28:29] offset:512
    global_load_dwordx4 v[44:47], v15, s[4:5] offset:640
    global_load_dwordx4 v[72:75], v14, s[28:29] offset:640
    global_load_dwordx4 v[48:51], v15, s[4:5] offset:768
    global_load_dwordx4 v[76:79], v14, s[28:29] offset:768
    v_mov_b32 v232, 0
    s_mov_b32 exec_lo, 0x10000000
    s_mov_b32 exec_hi, 0x10000000
    v_mov_b32 v232, 0x3f803f80
    s_mov_b64 exec, -1
    v_mov_b32 v233, v232
    v_mov_b64 v[234:235], v[232:233]
    v_mov_b64 v[236:237], v[232:233]
    v_mov_b64 v[238:239], v[232:233]
    v_mov_b64 v[240:241], v[232:233]
    v_mov_b64 v[242:243], v[232:233]
    v_mov_b64 v[244:245], v[232:233]
    v_mov_b64 v[246:247], v[232:233]
    v_mov_b64 v[248:249], v[232:233]
    v_mov_b64 v[250:251], v[232:233]
    v_mov_b64 v[252:253], v[232:233]
    v_mov_b64 v[254:255], v[232:233]
    v_mov_b32 v23, 0
    s_waitcnt vmcnt(0)
    v_dot2c_f32_bf16 v23, v24, v52
    v_dot2c_f32_bf16 v23, v25, v53
    v_dot2c_f32_bf16 v23, v26, v54
    v_dot2c_f32_bf16 v23, v27, v55
    v_dot2c_f32_bf16 v23, v28, v56
    v_dot2c_f32_bf16 v23, v29, v57
    v_dot2c_f32_bf16 v23, v30, v58
    v_dot2c_f32_bf16 v23, v31, v59
    v_dot2c_f32_bf16 v23, v32, v60
    v_dot2c_f32_bf16 v23, v33, v61
    v_dot2c_f32_bf16 v23, v34, v62
    v_dot2c_f32_bf16 v23, v35, v63
    v_dot2c_f32_bf16 v23, v36, v64
    v_dot2c_f32_bf16 v23, v37, v65
    v_dot2c_f32_bf16 v23, v38, v66
    v_dot2c_f32_bf16 v23, v39, v67
    v_dot2c_f32_bf16 v23, v40, v68
    v_dot2c_f32_bf16 v23, v41, v69
    v_dot2c_f32_bf16 v23, v42, v70
    v_dot2c_f32_bf16 v23, v43, v71
    v_dot2c_f32_bf16 v23, v44, v72
    v_dot2c_f32_bf16 v23, v45, v73
    v_dot2c_f32_bf16 v23, v46, v74
    v_dot2c_f32_bf16 v23, v47, v75
    v_dot2c_f32_bf16 v23, v48, v76
    v_dot2c_f32_bf16 v23, v49, v77
    v_dot2c_f32_bf16 v23, v50, v78
    v_dot2c_f32_bf16 v23, v51, v79
    s_nop 2
    v_add_f32_dpp v23, v23, v23 quad_perm:[1,0,3,2] row_mask:0xf bank_mask:0xf
    s_nop 1
    v_add_f32_dpp v23, v23, v23 quad_perm:[2,3,0,1] row_mask:0xf bank_mask:0xf
    s_nop 1
    v_add_f32_dpp v23, v23, v23 row_half_mirror row_mask:0xf bank_mask:0xf
    v_mul_f32 v23, 0xbfb8aa3b, v23
    v_exp_f32 v23, v23
    v_lshlrev_b32 v12, 2, v12
    v_add_f32 v23, 1.0, v23
    v_rcp_f32 v23, v23
    s_lshl_b32 s36, s3, 5
    s_add_u32 s36, s36, 8388608
    s_mov_b32 exec_lo, 0x01010101
    s_mov_b32 exec_hi, 0x01010101
    buffer_store_dword v23, v12, s[12:15], s36 offen sc1
    s_mov_b64 exec, -1
    s_waitcnt vmcnt(0)
    s_barrier
    s_cmp_lt_u32 s3, 4
    s_cbranch_scc1 L_attn
    s_sub_u32 s3, s3, 4
    s_cmp_lg_u32 s3, 0
    s_cbranch_scc1 T_w
    s_add_u32 s41, s61, 13893632
    v_lshlrev_b32 v12, 15, v0
    s_mov_b64 exec, 0xff
    buffer_store_dwordx2 v[8:9], v12, s[12:15], s41 offen sc1
    s_mov_b64 exec, -1
T_w:
    s_setprio 3
    s_mov_b32 s60, 0
T_role:
    ds_read_b32 v12, v10 offset:61448
    s_add_u32 s60, s60, 1
    s_cmp_gt_u32 s60, 3200000
    s_cbranch_scc1 L_end
    s_waitcnt lgkmcnt(0)
    v_readfirstlane_b32 s69, v12
    s_cmp_eq_u32 s69, 0
    s_cbranch_scc1 T_role
    s_sub_u32 s69, s69, 1
    s_bfe_u32 s39, s69, 0x30002
    v_lshrrev_b32 v24, 2, v0
    v_and_b32 v12, 3, v0
    v_mul_u32_u24 v24, 896, v24
    v_lshl_add_u32 v24, v12, 4, v24
    s_mul_i32 s16, s3, 100352
    s_lshl_b32 s17, s39, 7
    s_add_u32 s16, s16, s17
    s_mul_i32 s17, s3, 7168
    s_add_u32 s17, s17, 65536
    s_add_u32 s18, s17, 7168
    s_cmp_eq_u32 s39, 7
    s_cselect_b32 s18, 0, s18
    s_mov_b32 s60, 0
    s_branch T_s_1
T_s:
    s_sleep 2
T_s_1:
    ds_read_b32 v14, v10 offset:61452
    s_add_u32 s60, s60, 1
    s_cmp_gt_u32 s60, 3200000
    s_cbranch_scc1 L_end
    s_waitcnt lgkmcnt(0)
    v_cmp_ne_u32 vcc, 4, v14
    s_cbranch_vccnz T_s
    s_branch X_tail_wo
L_slow:
    s_waitcnt vmcnt(0)
    s_add_u32 s45, s38, 56
    s_lshl_b32 s45, s45, 9
    s_mov_b32 m0, s40
    v_mov_b32 v152, 0
    v_mov_b32 v120, 0
    v_mov_b32 v153, 0
    v_mov_b32 v121, 0
    v_mov_b32 v154, 0
    v_mov_b32 v122, 0
    v_mov_b32 v155, 0
    v_mov_b32 v123, 0
    v_mov_b32 v156, 0
    v_mov_b32 v124, 0
    v_mov_b32 v157, 0
    v_mov_b32 v125, 0
    v_mov_b32 v158, 0
    v_mov_b32 v126, 0
    v_mov_b32 v159, 0
    v_mov_b32 v127, 0
    v_mov_b32 v160, 0
    v_mov_b32 v128, 0
    v_mov_b32 v161, 0
    v_mov_b32 v129, 0
    v_mov_b32 v162, 0
    v_mov_b32 v130, 0
    v_mov_b32 v163, 0
    v_mov_b32 v131, 0
    v_mov_b32 v164, 0
    v_mov_b32 v132, 0
    v_mov_b32 v165, 0
    v_mov_b32 v133, 0
    v_mov_b32 v166, 0
    v_mov_b32 v134, 0
    v_mov_b32 v167, 0
    v_mov_b32 v135, 0
    v_mov_b32 v18, 0xff800000
S_pass:
    s_mov_b32 s43, 0
    s_mov_b32 s16, s45
S_loop:
    buffer_load_dwordx4 v[168:171], v4, s[12:15], s16 offen sc1
    buffer_load_dwordx4 v[172:175], v5, s[12:15], s16 offen offset:1024 sc1
    s_mov_b64 exec, s[30:31]
    buffer_load_dwordx4 v[24:27], v12, s[12:15], s16 offen sc1
    buffer_load_dwordx4 v[28:31], v13, s[12:15], s16 offen offset:1024 sc1
    s_mov_b64 exec, -1
    s_add_u32 s16, s16, 86016
    s_waitcnt vmcnt(0)
    v_mfma_f32_32x32x16_bf16 v[216:231], v[168:171], v[64:67], v[120:135]
    v_mfma_f32_32x32x16_bf16 v[216:231], v[172:175], v[68:71], v[216:231]
    s_nop 11
    s_waitcnt lgkmcnt(0)
    s_cmp_eq_u32 s44, 0
    s_cbranch_scc0 S_exp
    s_nop 0
    v_max3_f32 v18, v18, v216, v217
    v_max3_f32 v18, v18, v218, v219
    v_max3_f32 v18, v18, v220, v221
    v_max3_f32 v18, v18, v222, v223
    v_max3_f32 v18, v18, v224, v225
    v_max3_f32 v18, v18, v226, v227
    v_max3_f32 v18, v18, v228, v229
    v_max3_f32 v18, v18, v230, v231
    s_branch S_next
S_exp:
    v_exp_f32 v216, v216
    v_exp_f32 v217, v217
    v_exp_f32 v218, v218
    v_exp_f32 v219, v219
    v_exp_f32 v220, v220
    v_exp_f32 v221, v221
    v_exp_f32 v222, v222
    v_exp_f32 v223, v223
    v_exp_f32 v224, v224
    v_exp_f32 v225, v225
    v_exp_f32 v226, v226
    v_exp_f32 v227, v227
    v_exp_f32 v228, v228
    v_exp_f32 v229, v229
    v_exp_f32 v230, v230
    v_exp_f32 v231, v231
    s_nop 1
    v_smfmac_f32_32x32x32_bf16 v[152:167], v[24:27], v[216:223], v32
    v_smfmac_f32_32x32x32_bf16 v[152:167], v[28:31], v[224:231], v32
S_next:
    s_add_u32 s43, s43, 1
    s_cmp_lt_u32 s43, 64
    s_cbranch_scc1 S_loop
    s_nop 12
    s_cmp_eq_u32 s44, 1
    s_cbranch_scc1 A_norm
    s_mov_b32 s44, 1
    v_mov_b32 v19, v18
    s_nop 1
    v_permlane32_swap_b32 v18, v19
    s_nop 1
    v_max_f32 v18, v18, v19
    v_sub_f32 v120, 0, v18
    v_sub_f32 v121, 0, v18
    v_sub_f32 v122, 0, v18
    v_sub_f32 v123, 0, v18
    v_sub_f32 v124, 0, v18
    v_sub_f32 v125, 0, v18
    v_sub_f32 v126, 0, v18
    v_sub_f32 v127, 0, v18
    v_sub_f32 v128, 0, v18
    v_sub_f32 v129, 0, v18
    v_sub_f32 v130, 0, v18
    v_sub_f32 v131, 0, v18
    v_sub_f32 v132, 0, v18
    v_sub_f32 v133, 0, v18
    v_sub_f32 v134, 0, v18
    v_sub_f32 v135, 0, v18
    s_branch S_pass
L_end:
    s_endpgm
L_code_end:
.section .rodata,"a"
.p2align 6
.amdhsa_kernel gated_mix__mha_block__ssm_conv_s4d__prompt_kernel
  .amdhsa_next_free_vgpr 256
  .amdhsa_next_free_sgpr 96
  .amdhsa_accum_offset 256
  .amdhsa_group_segment_fixed_size 0
  .amdhsa_kernarg_size 112
  .amdhsa_user_sgpr_count 2
  .amdhsa_user_sgpr_kernarg_segment_ptr 1
  .amdhsa_system_sgpr_workgroup_id_x 1
  .amdhsa_ieee_mode 0
.end_amdhsa_kernel
```
